```python
import torch

def _softmax(x, axis=-1):
    return torch.softmax(x, dim=axis)
def _gelu(x):
    return torch.nn.functional.gelu(x, approximate="tanh")
def _silu(x):
    return torch.nn.functional.silu(x)
def _sigmoid(x):
    return torch.sigmoid(x)
def _layernorm(x, axis=-1, eps=1e-5):
    m = x.mean(dim=axis, keepdim=True)
    v = x.var(dim=axis, keepdim=True, unbiased=False)
    return (x - m) / torch.sqrt(v + eps)
def _scatter_add(tgt, idx, src, axis=0):
    return tgt.clone().index_add_(axis, idx, src)
def _segment_sum(src, seg, n):
    out = torch.zeros((n,) + src.shape[1:], dtype=src.dtype)
    return out.index_add_(0, seg, src)
def _pad(x, pw):
    flat = tuple(v for pair in reversed(pw) for v in pair)
    return torch.nn.functional.pad(x, flat)

kernel_name = 'interleave_layers__mha_block_cached__dense_activation_gelu__decode'

def setup_inputs():

    _w = (lambda a: (lambda t: t.to(torch.bfloat16) if t.is_floating_point() else t)(torch.as_tensor(a)))
    def _A_setup():
        B, Sq, D = 2, 1, 512
        H, Sk, Dh = 32, 8192, 128
        return {
            "x": _w((lambda *s: torch.randn(*s, dtype=torch.bfloat16) * 0.1)(B, Sq, D)),
            "k_cache": _w((lambda *s: torch.randn(*s, dtype=torch.bfloat16) * 0.8)(B, H, Sk, Dh)),
            "v_cache": _w((lambda *s: torch.randn(*s, dtype=torch.bfloat16) * 3.2)(B, H, Sk, Dh)),
            "wq": _w((lambda *s: torch.randn(*s, dtype=torch.bfloat16) * 0.8)(D, H * Dh) * (D ** -0.5)),
            "wo": _w((lambda *s: torch.randn(*s, dtype=torch.bfloat16) * 3.2)(H * Dh, D) * ((H * Dh) ** -0.5)),
        }
    _A_in = _A_setup()

    def _B_setup():
        B, S, D, F = 2, 1, 512, 1792
        return {
            "x": _w((lambda *s: torch.randn(*s, dtype=torch.bfloat16) * 0.1)(B, S, D)),
            "w1": _w((lambda *s: torch.randn(*s, dtype=torch.bfloat16) * 1.6)(D, F) * (D ** -0.5)),
            "b1": _w((lambda *s: torch.randn(*s, dtype=torch.bfloat16) * 1.6)(F) * 0.01),
            "w2": _w((lambda *s: torch.randn(*s, dtype=torch.bfloat16) * 0.4)(F, D) * (F ** -0.5)),
            "b2": _w((lambda *s: torch.randn(*s, dtype=torch.bfloat16) * 0.4)(D) * 0.01),
        }
    _B_in = _B_setup()

    return {
        "A_x": _A_in["x"],
        "A_k_cache": _A_in["k_cache"],
        "A_v_cache": _A_in["v_cache"],
        "A_wq": _A_in["wq"],
        "A_wo": _A_in["wo"],
        "B_x": _B_in["x"],
        "B_w1": _B_in["w1"],
        "B_b1": _B_in["b1"],
        "B_w2": _B_in["w2"],
        "B_b2": _B_in["b2"],
    }

def reference(A_x, A_k_cache, A_v_cache, A_wq, A_wo, B_x, B_w1, B_b1, B_w2, B_b2):
    def _A_ref(x, k_cache, v_cache, wq, wo):
        B, Sq, D = x.shape
        H, Dh = 32, 128
        q = (lambda x, *d: x.permute(*d))((x @ wq).reshape(B, Sq, H, Dh), 0, 2, 1, 3)
        scores = torch.einsum("bhqd,bhkd->bhqk", q, k_cache) * (Dh ** -0.5)
        p = _softmax(scores, axis=-1)
        o = torch.einsum("bhqk,bhkd->bhqd", p, v_cache)
        return (lambda x, *d: x.permute(*d))(o, 0, 2, 1, 3).reshape(B, Sq, H * Dh) @ wo

    def _B_ref(x, w1, b1, w2, b2):
        h = torch.einsum("bsd,df->bsf", x, w1) + b1
        h = _gelu(h)
        return torch.einsum("bsf,fd->bsd", h, w2) + b2

    x = A_x
    x = x + _A_ref(_layernorm(x, axis=-1), A_k_cache, A_v_cache, A_wq, A_wo)
    x = x + _B_ref(_layernorm(x, axis=-1), B_w1, B_b1, B_w2, B_b2)
    x = x + _A_ref(_layernorm(x, axis=-1), A_k_cache, A_v_cache, A_wq, A_wo)
    x = x + _B_ref(_layernorm(x, axis=-1), B_w1, B_b1, B_w2, B_b2)
    return x
```

```asm
; @launch grid=(256,1,1) block=(256,1,1) lds=163840
.amdgcn_target "amdgcn-amd-amdhsa--gfx950"
.text
.globl interleave_layers__mha_block_cached__dense_activation_gelu__decode_kernel
.p2align 8
.type interleave_layers__mha_block_cached__dense_activation_gelu__decode_kernel,@function
interleave_layers__mha_block_cached__dense_activation_gelu__decode_kernel:
    s_cmp_ge_u32 s2, 256
    s_cbranch_scc1 L_exit
    s_load_dwordx4 s[4:7], s[0:1], 8
    s_load_dwordx2 s[36:37], s[0:1], 0
    s_load_dwordx4 s[20:23], s[0:1], 24
    s_load_dwordx2 s[64:65], s[0:1], 96
    s_load_dwordx2 s[24:25], s[0:1], 48
    s_load_dwordx2 s[28:29], s[0:1], 56
    s_load_dwordx2 s[26:27], s[0:1], 64
    s_load_dwordx2 s[30:31], s[0:1], 72
    s_load_dwordx4 s[32:35], s[0:1], 80
    v_lshrrev_b32 v70, 6, v0
    v_and_b32 v0, 63, v0
    v_readfirstlane_b32 s38, v70
    s_and_b32 s39, s2, 7
    s_lshl_b32 s39, s39, 2
    s_bfe_u32 s40, s2, 0x20003
    s_add_u32 s39, s39, s40
    s_lshr_b32 s40, s2, 5
    s_lshr_b32 s41, s40, 2
    s_and_b32 s42, s40, 3
    s_lshl_b32 s61, s39, 3
    s_add_u32 s61, s61, s40
    s_lshl_b32 s61, s61, 14
    s_lshl_b32 s72, s2, 14
    s_mov_b32 s46, 0
    s_mul_i32 s43, s38, 32768
    s_lshl_b32 s44, s38, 12
    s_add_u32 s44, s44, 131072
    s_mov_b32 s58, 0x00010001
    s_mov_b32 s59, 0x00010001
    s_mov_b32 s62, 0x00ff00ff
    s_mov_b32 s63, 0x00ff00ff
    s_mov_b32 s68, 0x00030003
    s_mov_b32 s69, 0x00030003
    s_mov_b32 s70, 0x00070007
    s_mov_b32 s71, 0x00070007
    s_mov_b32 s60, 0x3e0293ee
    s_lshl_b32 s54, s39, 21
    s_bfe_i32 s55, s38, 0x10000
    s_and_b32 s79, s55, 32768
    s_bfe_i32 s55, s38, 0x10001
    s_and_b32 s55, s55, 1572864
    s_xor_b32 s79, s79, s55
    s_bfe_i32 s55, s42, 0x10000
    s_and_b32 s55, s55, 282624
    s_xor_b32 s79, s79, s55
    s_bfe_i32 s55, s42, 0x10001
    s_and_b32 s55, s55, 2015232
    s_xor_b32 s79, s79, s55
    s_bfe_i32 s55, s41, 0x10000
    s_and_b32 s55, s55, 323584
    s_xor_b32 s79, s79, s55
    v_lshlrev_b32 v1, 4, v0
    v_lshrrev_b32 v71, 4, v0
    v_lshlrev_b32 v71, 13, v71
    v_and_b32 v70, 15, v0
    v_lshl_add_u32 v16, v70, 4, v71
    s_lshl_b32 s45, s38, 20
    s_lshl_b32 s57, s39, 8
    s_add_u32 s45, s45, s57
    s_waitcnt lgkmcnt(0)
    s_add_u32 s8, s6, s54
    s_addc_u32 s9, s7, 0
    s_and_b32 s9, s9, 0xffff
    s_mov_b32 s10, 69206016
    s_mov_b32 s11, 0x20000
    s_add_u32 s4, s4, s54
    s_addc_u32 s5, s5, 0
    s_and_b32 s5, s5, 0xffff
    s_mov_b32 s6, 69206016
    s_mov_b32 s7, 0x20000
    s_mov_b32 s12, s64
    s_and_b32 s13, s65, 0xffff
    s_mov_b32 s14, 9437184
    s_mov_b32 s15, 0x20000
    s_mov_b32 s99, 0
    s_mov_b32 s100, 0
    v_mov_b32 v48, -1
    v_mov_b32 v49, -1
    v_mov_b32 v50, -1
    v_mov_b32 v51, -1
    s_cmp_eq_u32 s38, 3
    s_cselect_b32 s55, s72, s61
    s_lshl_b32 s54, s38, 10
    s_add_u32 s55, s54, s55
    buffer_store_dwordx4 v[48:51], v1, s[12:15], s55 offen sc1
    s_add_u32 s55, s55, 8192
    buffer_store_dwordx4 v[48:51], v1, s[12:15], s55 offen sc1
    s_add_u32 s55, s55, 5234688
    buffer_store_dwordx4 v[48:51], v1, s[12:15], s55 offen sc1
    s_cmp_lt_u32 s2, 112
    s_cbranch_scc0 Lnf_1
    s_add_u32 s54, s54, s72
    s_add_u32 s54, s54, 4096
    s_add_u32 s55, s54, 8192
    buffer_store_dwordx4 v[48:51], v1, s[12:15], s54 offen sc1
    buffer_store_dwordx4 v[48:51], v1, s[12:15], s55 offen sc1
    s_add_u32 s55, s54, 5242880
    buffer_store_dwordx4 v[48:51], v1, s[12:15], s55 offen sc1
Lnf_1:
    s_mov_b32 s16, s36
    s_and_b32 s17, s37, 0xffff
    s_mov_b32 s18, 2048
    s_mov_b32 s19, 0x20000
    buffer_load_dwordx4 v[56:59], v1, s[16:19], 0 offen
    buffer_load_dwordx4 v[232:235], v1, s[16:19], 0 offen offset:1024
    s_mov_b32 s16, s20
    s_and_b32 s17, s21, 0xffff
    s_mov_b32 s18, 4194304
    s_mov_b32 s19, 0x20000
    v_lshlrev_b32 v1, 4, v0
    v_and_b32 v70, 15, v0
    v_lshrrev_b32 v71, 4, v0
    v_add_u32 v48, 0, v71
    v_xor_b32 v48, v48, v70
    v_lshlrev_b32 v48, 4, v48
    v_lshl_add_u32 v2, v71, 8, v48
    v_add_u32 v48, 4, v71
    v_xor_b32 v48, v48, v70
    v_lshlrev_b32 v48, 4, v48
    v_lshl_add_u32 v3, v71, 8, v48
    v_add_u32 v48, 8, v71
    v_xor_b32 v48, v48, v70
    v_lshlrev_b32 v48, 4, v48
    v_lshl_add_u32 v4, v71, 8, v48
    v_add_u32 v48, 12, v71
    v_xor_b32 v48, v48, v70
    v_lshlrev_b32 v48, 4, v48
    v_lshl_add_u32 v5, v71, 8, v48
    v_add_u32 v48, 0, v71
    v_xor_b32 v48, v48, v70
    v_lshlrev_b32 v48, 4, v48
    v_lshl_add_u32 v48, v70, 8, v48
    v_add_u32 v6, s43, v48
    v_add_u32 v48, 4, v71
    v_xor_b32 v48, v48, v70
    v_lshlrev_b32 v48, 4, v48
    v_lshl_add_u32 v48, v70, 8, v48
    v_add_u32 v7, s43, v48
    v_add_u32 v48, 8, v71
    v_xor_b32 v48, v48, v70
    v_lshlrev_b32 v48, 4, v48
    v_lshl_add_u32 v48, v70, 8, v48
    v_add_u32 v8, s43, v48
    v_add_u32 v48, 12, v71
    v_xor_b32 v48, v48, v70
    v_lshlrev_b32 v48, 4, v48
    v_lshl_add_u32 v48, v70, 8, v48
    v_add_u32 v9, s43, v48
    v_and_b32 v48, 7, v70
    v_mov_b32 v49, 0xffff
    v_mov_b32 v50, 0xffff0000
    v_mov_b32 v10, 0
    v_cmp_eq_u32 vcc, 0, v48
s_nop 1
    v_cndmask_b32 v10, v10, v49, vcc
    v_cmp_eq_u32 vcc, 1, v48
s_nop 1
    v_cndmask_b32 v10, v10, v50, vcc
    v_mov_b32 v11, 0
    v_cmp_eq_u32 vcc, 2, v48
s_nop 1
    v_cndmask_b32 v11, v11, v49, vcc
    v_cmp_eq_u32 vcc, 3, v48
s_nop 1
    v_cndmask_b32 v11, v11, v50, vcc
    v_mov_b32 v12, 0
    v_cmp_eq_u32 vcc, 4, v48
s_nop 1
    v_cndmask_b32 v12, v12, v49, vcc
    v_cmp_eq_u32 vcc, 5, v48
s_nop 1
    v_cndmask_b32 v12, v12, v50, vcc
    v_mov_b32 v13, 0
    v_cmp_eq_u32 vcc, 6, v48
s_nop 1
    v_cndmask_b32 v13, v13, v49, vcc
    v_cmp_eq_u32 vcc, 7, v48
s_nop 1
    v_cndmask_b32 v13, v13, v50, vcc
    s_mul_i32 s54, s38, 1152
    s_add_u32 s54, s54, 147456
    v_and_b32 v48, 1, v71
    v_mul_u32_u24 v48, 576, v48
    v_lshrrev_b32 v49, 1, v71
    v_lshl_add_u32 v49, v70, 1, v49
    v_lshl_add_u32 v48, v49, 2, v48
    v_add_u32 v14, s54, v48
    v_lshrrev_b32 v48, 3, v70
    v_lshl_add_u32 v48, v48, 2, v71
    v_mul_u32_u24 v48, 144, v48
    v_add_u32 v15, s54, v48
    s_add_u32 m0, s43, 0
    s_xor_b32 s66, s79, 0
    buffer_load_dwordx4 v2, s[4:7], s66 offen offset:0 nt lds
    buffer_load_dwordx4 v3, s[4:7], s66 offen offset:1024 nt lds
    buffer_load_dwordx4 v4, s[4:7], s66 offen offset:2048 nt lds
    buffer_load_dwordx4 v5, s[4:7], s66 offen offset:3072 nt lds
    buffer_load_dwordx4 a[0:3], v16, s[16:19], s45 offen
    s_add_u32 s45, s45, 32768
    buffer_load_dwordx4 a[4:7], v16, s[16:19], s45 offen
    s_add_u32 s45, s45, 32768
    buffer_load_dwordx4 a[8:11], v16, s[16:19], s45 offen
    s_add_u32 s45, s45, 32768
    buffer_load_dwordx4 a[12:15], v16, s[16:19], s45 offen
    s_add_u32 m0, s43, 4096
    s_xor_b32 s66, s79, 303104
    buffer_load_dwordx4 v2, s[4:7], s66 offen offset:0 nt lds
    buffer_load_dwordx4 v3, s[4:7], s66 offen offset:1024 nt lds
    buffer_load_dwordx4 v4, s[4:7], s66 offen offset:2048 nt lds
    buffer_load_dwordx4 v5, s[4:7], s66 offen offset:3072 nt lds
    s_add_u32 s45, s45, 32768
    buffer_load_dwordx4 a[16:19], v16, s[16:19], s45 offen
    s_add_u32 s45, s45, 32768
    buffer_load_dwordx4 a[20:23], v16, s[16:19], s45 offen
    s_add_u32 s45, s45, 32768
    buffer_load_dwordx4 a[24:27], v16, s[16:19], s45 offen
    s_add_u32 s45, s45, 32768
    buffer_load_dwordx4 a[28:31], v16, s[16:19], s45 offen
    s_add_u32 m0, s43, 8192
    s_xor_b32 s66, s79, 933888
    buffer_load_dwordx4 v2, s[4:7], s66 offen offset:0 nt lds
    buffer_load_dwordx4 v3, s[4:7], s66 offen offset:1024 nt lds
    buffer_load_dwordx4 v4, s[4:7], s66 offen offset:2048 nt lds
    buffer_load_dwordx4 v5, s[4:7], s66 offen offset:3072 nt lds
    s_add_u32 s45, s45, 32768
    buffer_load_dwordx4 a[32:35], v16, s[16:19], s45 offen
    s_add_u32 s45, s45, 32768
    buffer_load_dwordx4 a[36:39], v16, s[16:19], s45 offen
    s_add_u32 s45, s45, 32768
    buffer_load_dwordx4 a[40:43], v16, s[16:19], s45 offen
    s_add_u32 s45, s45, 32768
    buffer_load_dwordx4 a[44:47], v16, s[16:19], s45 offen
    s_add_u32 m0, s43, 12288
    s_xor_b32 s66, s79, 712704
    buffer_load_dwordx4 v2, s[4:7], s66 offen offset:0 nt lds
    buffer_load_dwordx4 v3, s[4:7], s66 offen offset:1024 nt lds
    buffer_load_dwordx4 v4, s[4:7], s66 offen offset:2048 nt lds
    buffer_load_dwordx4 v5, s[4:7], s66 offen offset:3072 nt lds
    s_add_u32 s45, s45, 32768
    buffer_load_dwordx4 a[48:51], v16, s[16:19], s45 offen
    s_add_u32 s45, s45, 32768
    buffer_load_dwordx4 a[52:55], v16, s[16:19], s45 offen
    s_add_u32 s45, s45, 32768
    buffer_load_dwordx4 a[56:59], v16, s[16:19], s45 offen
    s_add_u32 s45, s45, 32768
    buffer_load_dwordx4 a[60:63], v16, s[16:19], s45 offen
    s_add_u32 m0, s43, 16384
    s_xor_b32 s66, s79, 229376
    buffer_load_dwordx4 v2, s[4:7], s66 offen offset:0 nt lds
    buffer_load_dwordx4 v3, s[4:7], s66 offen offset:1024 nt lds
    buffer_load_dwordx4 v4, s[4:7], s66 offen offset:2048 nt lds
    buffer_load_dwordx4 v5, s[4:7], s66 offen offset:3072 nt lds
    s_add_u32 s45, s45, 32768
    buffer_load_dwordx4 a[64:67], v16, s[16:19], s45 offen
    s_add_u32 s45, s45, 32768
    buffer_load_dwordx4 a[68:71], v16, s[16:19], s45 offen
    s_add_u32 s45, s45, 32768
    buffer_load_dwordx4 a[72:75], v16, s[16:19], s45 offen
    s_add_u32 s45, s45, 32768
    buffer_load_dwordx4 a[76:79], v16, s[16:19], s45 offen
    s_add_u32 m0, s43, 20480
    s_xor_b32 s66, s79, 466944
    buffer_load_dwordx4 v2, s[4:7], s66 offen offset:0 nt lds
    buffer_load_dwordx4 v3, s[4:7], s66 offen offset:1024 nt lds
    buffer_load_dwordx4 v4, s[4:7], s66 offen offset:2048 nt lds
    buffer_load_dwordx4 v5, s[4:7], s66 offen offset:3072 nt lds
    s_add_u32 s45, s45, 32768
    buffer_load_dwordx4 a[80:83], v16, s[16:19], s45 offen
    s_add_u32 s45, s45, 32768
    buffer_load_dwordx4 a[84:87], v16, s[16:19], s45 offen
    s_add_u32 s45, s45, 32768
    buffer_load_dwordx4 a[88:91], v16, s[16:19], s45 offen
    s_add_u32 s45, s45, 32768
    buffer_load_dwordx4 a[92:95], v16, s[16:19], s45 offen
    s_add_u32 m0, s43, 24576
    s_xor_b32 s66, s79, 901120
    buffer_load_dwordx4 v2, s[4:7], s66 offen offset:0 nt lds
    buffer_load_dwordx4 v3, s[4:7], s66 offen offset:1024 nt lds
    buffer_load_dwordx4 v4, s[4:7], s66 offen offset:2048 nt lds
    buffer_load_dwordx4 v5, s[4:7], s66 offen offset:3072 nt lds
    s_add_u32 s45, s45, 32768
    buffer_load_dwordx4 a[96:99], v16, s[16:19], s45 offen
    s_add_u32 s45, s45, 32768
    buffer_load_dwordx4 a[100:103], v16, s[16:19], s45 offen
    s_add_u32 s45, s45, 32768
    buffer_load_dwordx4 a[104:107], v16, s[16:19], s45 offen
    v_and_b32 v48, 31, v0
    v_lshlrev_b32 v48, 3, v48
    v_add_u32 v48, 156736, v48
    v_mov_b32 v50, 0x3f803f80
    v_mov_b32 v51, 0x3f803f80
    ds_write_b64 v48, v[50:51]
    s_waitcnt vmcnt(55)
    v_lshlrev_b32 v48, 16, v56
    v_and_b32 v49, 0xffff0000, v56
    v_lshlrev_b32 v50, 16, v57
    v_and_b32 v51, 0xffff0000, v57
    v_lshlrev_b32 v52, 16, v58
    v_and_b32 v53, 0xffff0000, v58
    v_lshlrev_b32 v54, 16, v59
    v_and_b32 v55, 0xffff0000, v59
    v_add_f32 v68, v48, v49
    v_mul_f32 v69, v48, v48
    v_fmac_f32 v69, v49, v49
    v_add_f32 v68, v68, v50
    v_fmac_f32 v69, v50, v50
    v_add_f32 v68, v68, v51
    v_fmac_f32 v69, v51, v51
    v_add_f32 v68, v68, v52
    v_fmac_f32 v69, v52, v52
    v_add_f32 v68, v68, v53
    v_fmac_f32 v69, v53, v53
    v_add_f32 v68, v68, v54
    v_fmac_f32 v69, v54, v54
    v_add_f32 v68, v68, v55
    v_fmac_f32 v69, v55, v55
s_nop 0
    v_add_f32_dpp v68, v68, v68 row_ror:8 row_mask:0xf bank_mask:0xf
    v_add_f32_dpp v69, v69, v69 row_ror:8 row_mask:0xf bank_mask:0xf
s_nop 0
    v_add_f32_dpp v68, v68, v68 row_ror:4 row_mask:0xf bank_mask:0xf
    v_add_f32_dpp v69, v69, v69 row_ror:4 row_mask:0xf bank_mask:0xf
s_nop 0
    v_add_f32_dpp v68, v68, v68 row_ror:2 row_mask:0xf bank_mask:0xf
    v_add_f32_dpp v69, v69, v69 row_ror:2 row_mask:0xf bank_mask:0xf
s_nop 0
    v_add_f32_dpp v68, v68, v68 row_ror:1 row_mask:0xf bank_mask:0xf
    v_add_f32_dpp v69, v69, v69 row_ror:1 row_mask:0xf bank_mask:0xf
    v_mov_b32 v70, v68
    v_mov_b32 v71, v69
s_nop 0
    v_permlane16_swap_b32 v70, v68
    v_permlane16_swap_b32 v71, v69
    v_add_f32 v68, v70, v68
    v_add_f32 v69, v71, v69
    v_mov_b32 v70, v68
    v_mov_b32 v71, v69
s_nop 0
    v_permlane32_swap_b32 v70, v68
    v_permlane32_swap_b32 v71, v69
    v_add_f32 v68, v70, v68
    v_add_f32 v69, v71, v69
    v_mul_f32 v68, 0x3b000000, v68
    v_mul_f32 v69, 0x3b000000, v69
    v_fma_f32 v69, -v68, v68, v69
    v_max_f32 v69, 0, v69
    v_add_f32 v69, 0x3727c5ac, v69
    v_rsq_f32 v69, v69
    v_sub_f32 v48, v48, v68
    v_sub_f32 v49, v49, v68
    v_sub_f32 v50, v50, v68
    v_sub_f32 v51, v51, v68
    v_sub_f32 v52, v52, v68
    v_sub_f32 v53, v53, v68
    v_sub_f32 v54, v54, v68
    v_sub_f32 v55, v55, v68
    v_mul_f32 v48, v69, v48
    v_mul_f32 v49, v69, v49
    v_mul_f32 v50, v69, v50
    v_mul_f32 v51, v69, v51
    v_mul_f32 v52, v69, v52
    v_mul_f32 v53, v69, v53
    v_mul_f32 v54, v69, v54
    v_mul_f32 v55, v69, v55
    v_cvt_pk_bf16_f32 v48, v48, v48
    v_cvt_pk_bf16_f32 v49, v49, v49
    v_cvt_pk_bf16_f32 v50, v50, v50
    v_cvt_pk_bf16_f32 v51, v51, v51
    v_cvt_pk_bf16_f32 v52, v52, v52
    v_cvt_pk_bf16_f32 v53, v53, v53
    v_cvt_pk_bf16_f32 v54, v54, v54
    v_cvt_pk_bf16_f32 v55, v55, v55
    s_mul_i32 s54, s38, 1152
    s_add_u32 s54, s54, 147456
    v_and_b32 v70, 15, v0
    v_lshlrev_b32 v70, 2, v70
    v_add_u32 v70, s54, v70
    s_lshl_b32 s54, s38, 4
    s_mov_b64 s[52:53], 0xffff
    s_lshl_b64 s[52:53], s[52:53], s54
    s_mov_b64 exec, s[52:53]
    ds_write_b32 v70, v48 offset:0
    ds_write_b32 v70, v49 offset:144
    ds_write_b32 v70, v50 offset:288
    ds_write_b32 v70, v51 offset:432
    ds_write_b32 v70, v52 offset:576
    ds_write_b32 v70, v53 offset:720
    ds_write_b32 v70, v54 offset:864
    ds_write_b32 v70, v55 offset:1008
    s_mov_b64 exec, -1
    s_waitcnt lgkmcnt(0)
    ds_read_b128 v[40:43], v15 offset:0
    s_waitcnt lgkmcnt(0)
    ds_read_b128 v[44:47], v15 offset:16
    v_and_b32 v32, v40, v10
    v_and_b32 v33, v40, v11
    v_and_b32 v34, v40, v12
    v_and_b32 v35, v40, v13
    s_waitcnt vmcnt(50)
    v_and_b32 v36, v41, v10
    v_and_b32 v37, v41, v11
    v_mfma_f32_16x16x32_bf16 v[60:63], a[0:3], v[32:35], 0
    s_waitcnt vmcnt(49)
    v_and_b32 v38, v41, v12
    v_and_b32 v39, v41, v13
    v_mfma_f32_16x16x32_bf16 v[64:67], a[4:7], v[32:35], 0
    s_add_u32 s45, s45, 32768
    buffer_load_dwordx4 a[108:111], v16, s[16:19], s45 offen
    s_add_u32 m0, s43, 28672
    s_xor_b32 s66, s79, 614400
    buffer_load_dwordx4 v2, s[4:7], s66 offen offset:0 nt lds
    buffer_load_dwordx4 v3, s[4:7], s66 offen offset:1024 nt lds
    buffer_load_dwordx4 v4, s[4:7], s66 offen offset:2048 nt lds
    buffer_load_dwordx4 v5, s[4:7], s66 offen offset:3072 nt lds
    s_add_u32 s45, s45, 32768
    buffer_load_dwordx4 a[112:115], v16, s[16:19], s45 offen
    s_add_u32 s45, s45, 32768
    buffer_load_dwordx4 a[116:119], v16, s[16:19], s45 offen
    s_add_u32 s45, s45, 32768
    buffer_load_dwordx4 a[120:123], v16, s[16:19], s45 offen
    s_add_u32 s45, s45, 32768
    buffer_load_dwordx4 a[124:127], v16, s[16:19], s45 offen
    s_xor_b32 s67, s79, 1994752
    buffer_load_dwordx4 a[128:131], v1, s[8:11], s67 offen offset:0 nt
    buffer_load_dwordx4 a[132:135], v1, s[8:11], s67 offen offset:1024 nt
    s_waitcnt vmcnt(59)
    v_and_b32 v32, v42, v10
    v_and_b32 v33, v42, v11
    v_mfma_f32_16x16x32_bf16 v[60:63], a[8:11], v[36:39], v[60:63]
    s_waitcnt vmcnt(58)
    v_and_b32 v34, v42, v12
    v_and_b32 v35, v42, v13
    v_mfma_f32_16x16x32_bf16 v[64:67], a[12:15], v[36:39], v[64:67]
    buffer_load_dwordx4 a[136:139], v1, s[8:11], s67 offen offset:2048 nt
    buffer_load_dwordx4 a[140:143], v1, s[8:11], s67 offen offset:3072 nt
    s_waitcnt vmcnt(55)
    v_and_b32 v36, v43, v10
    v_and_b32 v37, v43, v11
    v_mfma_f32_16x16x32_bf16 v[60:63], a[16:19], v[32:35], v[60:63]
    s_waitcnt vmcnt(54)
    v_and_b32 v38, v43, v12
    v_and_b32 v39, v43, v13
    v_mfma_f32_16x16x32_bf16 v[64:67], a[20:23], v[32:35], v[64:67]
    s_xor_b32 s67, s79, 1757184
    buffer_load_dwordx4 a[144:147], v1, s[8:11], s67 offen offset:0 nt
    buffer_load_dwordx4 a[148:151], v1, s[8:11], s67 offen offset:1024 nt
    buffer_load_dwordx4 a[152:155], v1, s[8:11], s67 offen offset:2048 nt
    buffer_load_dwordx4 a[156:159], v1, s[8:11], s67 offen offset:3072 nt
    s_xor_b32 s67, s79, 1060864
    buffer_load_dwordx4 a[160:163], v1, s[8:11], s67 offen offset:0 nt
    buffer_load_dwordx4 a[164:167], v1, s[8:11], s67 offen offset:1024 nt
    s_waitcnt lgkmcnt(0)
    s_waitcnt vmcnt(59)
    v_and_b32 v32, v44, v10
    v_and_b32 v33, v44, v11
    v_mfma_f32_16x16x32_bf16 v[60:63], a[24:27], v[36:39], v[60:63]
    s_waitcnt vmcnt(58)
    v_and_b32 v34, v44, v12
    v_and_b32 v35, v44, v13
    v_mfma_f32_16x16x32_bf16 v[64:67], a[28:31], v[36:39], v[64:67]
    ds_read_b128 v[40:43], v15 offset:32
    buffer_load_dwordx4 a[168:171], v1, s[8:11], s67 offen offset:2048 nt
    buffer_load_dwordx4 a[172:175], v1, s[8:11], s67 offen offset:3072 nt
    s_waitcnt vmcnt(55)
    v_and_b32 v36, v45, v10
    v_and_b32 v37, v45, v11
    v_mfma_f32_16x16x32_bf16 v[60:63], a[32:35], v[32:35], v[60:63]
    s_waitcnt vmcnt(54)
    v_and_b32 v38, v45, v12
    v_and_b32 v39, v45, v13
    v_mfma_f32_16x16x32_bf16 v[64:67], a[36:39], v[32:35], v[64:67]
    s_xor_b32 s67, s79, 1347584
    buffer_load_dwordx4 a[176:179], v1, s[8:11], s67 offen offset:0 nt
    buffer_load_dwordx4 a[180:183], v1, s[8:11], s67 offen offset:1024 nt
    buffer_load_dwordx4 a[184:187], v1, s[8:11], s67 offen offset:2048 nt
    buffer_load_dwordx4 a[188:191], v1, s[8:11], s67 offen offset:3072 nt
    s_xor_b32 s67, s79, 1961984
    buffer_load_dwordx4 a[192:195], v1, s[8:11], s67 offen offset:0 nt
    buffer_load_dwordx4 a[196:199], v1, s[8:11], s67 offen offset:1024 nt
    s_waitcnt vmcnt(59)
    v_and_b32 v32, v46, v10
    v_and_b32 v33, v46, v11
    v_mfma_f32_16x16x32_bf16 v[60:63], a[40:43], v[36:39], v[60:63]
    s_waitcnt vmcnt(58)
    v_and_b32 v34, v46, v12
    v_and_b32 v35, v46, v13
    v_mfma_f32_16x16x32_bf16 v[64:67], a[44:47], v[36:39], v[64:67]
    buffer_load_dwordx4 a[200:203], v1, s[8:11], s67 offen offset:2048 nt
    buffer_load_dwordx4 a[204:207], v1, s[8:11], s67 offen offset:3072 nt
    s_waitcnt vmcnt(55)
    v_and_b32 v36, v47, v10
    v_and_b32 v37, v47, v11
    v_mfma_f32_16x16x32_bf16 v[60:63], a[48:51], v[32:35], v[60:63]
    s_waitcnt vmcnt(54)
    v_and_b32 v38, v47, v12
    v_and_b32 v39, v47, v13
    v_mfma_f32_16x16x32_bf16 v[64:67], a[52:55], v[32:35], v[64:67]
    s_xor_b32 s67, s79, 1658880
    buffer_load_dwordx4 a[208:211], v1, s[8:11], s67 offen offset:0 nt
    buffer_load_dwordx4 a[212:215], v1, s[8:11], s67 offen offset:1024 nt
    buffer_load_dwordx4 a[216:219], v1, s[8:11], s67 offen offset:2048 nt
    buffer_load_dwordx4 a[220:223], v1, s[8:11], s67 offen offset:3072 nt
    s_waitcnt lgkmcnt(0)
    s_waitcnt vmcnt(57)
    v_and_b32 v32, v40, v10
    v_and_b32 v33, v40, v11
    v_mfma_f32_16x16x32_bf16 v[60:63], a[56:59], v[36:39], v[60:63]
    s_waitcnt vmcnt(56)
    v_and_b32 v34, v40, v12
    v_and_b32 v35, v40, v13
    v_mfma_f32_16x16x32_bf16 v[64:67], a[60:63], v[36:39], v[64:67]
    ds_read_b128 v[44:47], v15 offset:48
    s_waitcnt vmcnt(51)
    v_and_b32 v36, v41, v10
    v_and_b32 v37, v41, v11
    v_mfma_f32_16x16x32_bf16 v[60:63], a[64:67], v[32:35], v[60:63]
    s_waitcnt vmcnt(50)
    v_and_b32 v38, v41, v12
    v_and_b32 v39, v41, v13
    v_mfma_f32_16x16x32_bf16 v[64:67], a[68:71], v[32:35], v[64:67]
    s_waitcnt vmcnt(49)
    v_and_b32 v32, v42, v10
    v_and_b32 v33, v42, v11
    v_mfma_f32_16x16x32_bf16 v[60:63], a[72:75], v[36:39], v[60:63]
    s_waitcnt vmcnt(48)
    v_and_b32 v34, v42, v12
    v_and_b32 v35, v42, v13
    v_mfma_f32_16x16x32_bf16 v[64:67], a[76:79], v[36:39], v[64:67]
    s_waitcnt vmcnt(43)
    v_and_b32 v36, v43, v10
    v_and_b32 v37, v43, v11
    v_mfma_f32_16x16x32_bf16 v[60:63], a[80:83], v[32:35], v[60:63]
    s_waitcnt vmcnt(42)
    v_and_b32 v38, v43, v12
    v_and_b32 v39, v43, v13
    v_mfma_f32_16x16x32_bf16 v[64:67], a[84:87], v[32:35], v[64:67]
    s_waitcnt lgkmcnt(0)
    s_waitcnt vmcnt(41)
    v_and_b32 v32, v44, v10
    v_and_b32 v33, v44, v11
    v_mfma_f32_16x16x32_bf16 v[60:63], a[88:91], v[36:39], v[60:63]
    s_waitcnt vmcnt(40)
    v_and_b32 v34, v44, v12
    v_and_b32 v35, v44, v13
    v_mfma_f32_16x16x32_bf16 v[64:67], a[92:95], v[36:39], v[64:67]
    s_waitcnt vmcnt(35)
    v_and_b32 v36, v45, v10
    v_and_b32 v37, v45, v11
    v_mfma_f32_16x16x32_bf16 v[60:63], a[96:99], v[32:35], v[60:63]
    s_waitcnt vmcnt(34)
    v_and_b32 v38, v45, v12
    v_and_b32 v39, v45, v13
    v_mfma_f32_16x16x32_bf16 v[64:67], a[100:103], v[32:35], v[64:67]
    s_waitcnt vmcnt(33)
    v_and_b32 v32, v46, v10
    v_and_b32 v33, v46, v11
    v_mfma_f32_16x16x32_bf16 v[60:63], a[104:107], v[36:39], v[60:63]
    s_waitcnt vmcnt(32)
    v_and_b32 v34, v46, v12
    v_and_b32 v35, v46, v13
    v_mfma_f32_16x16x32_bf16 v[64:67], a[108:111], v[36:39], v[64:67]
    s_waitcnt vmcnt(27)
    v_and_b32 v36, v47, v10
    v_and_b32 v37, v47, v11
    v_mfma_f32_16x16x32_bf16 v[60:63], a[112:115], v[32:35], v[60:63]
    s_waitcnt vmcnt(26)
    v_and_b32 v38, v47, v12
    v_and_b32 v39, v47, v13
    v_mfma_f32_16x16x32_bf16 v[64:67], a[116:119], v[32:35], v[64:67]
    s_waitcnt vmcnt(25)
    v_mfma_f32_16x16x32_bf16 v[60:63], a[120:123], v[36:39], v[60:63]
    s_waitcnt vmcnt(24)
    v_mfma_f32_16x16x32_bf16 v[64:67], a[124:127], v[36:39], v[64:67]
    v_and_b32 v70, 15, v0
    v_lshrrev_b32 v71, 3, v70
    s_lshl_b32 s54, s38, 1
    v_add_u32 v71, s54, v71
    v_lshlrev_b32 v71, 9, v71
    v_and_b32 v70, 7, v70
    v_lshl_add_u32 v71, v70, 2, v71
    v_lshrrev_b32 v70, 4, v0
    v_lshl_add_u32 v71, v70, 7, v71
    v_add_u32 v71, 152064, v71
    v_cndmask_b32 v56, v64, v60, s[62:63]
    v_cndmask_b32 v57, v65, v61, s[62:63]
    v_cndmask_b32 v58, v66, v62, s[62:63]
    v_cndmask_b32 v59, v67, v63, s[62:63]
    ds_write_b32 v71, v56 offset:0
    ds_write_b32 v71, v57 offset:32
    ds_write_b32 v71, v58 offset:64
    ds_write_b32 v71, v59 offset:96
    s_and_b32 s54, s38, 1
    s_lshl_b32 s54, s54, 8
    v_lshlrev_b32 v70, 2, v0
    v_add_u32 v70, s54, v70
    v_lshrrev_b32 v71, 1, v70
    v_add_u32 v71, 156992, v71
    v_add_u32 v70, 152064, v70
    s_waitcnt lgkmcnt(0)
    s_barrier
    ds_read_b32 v48, v70 offset:0
    ds_read_b32 v49, v70 offset:512
    ds_read_b32 v50, v70 offset:1024
    ds_read_b32 v51, v70 offset:1536
    ds_read_b32 v52, v70 offset:2048
    ds_read_b32 v53, v70 offset:2560
    ds_read_b32 v54, v70 offset:3072
    ds_read_b32 v55, v70 offset:3584
    s_cmp_lg_u32 s38, 0
    s_cbranch_scc1 Larr_2
    s_mov_b32 s16, s34
    s_and_b32 s17, s35, 0xffff
    s_mov_b32 s18, 256
    s_mov_b32 s19, 0x20000
    s_lshl_b32 s55, s39, 2
    v_mov_b32 v56, s55
    s_getreg_b32 s56, hwreg(HW_REG_XCC_ID, 0, 4)
    s_mul_i32 s57, s56, s56
    s_lshl_b32 s57, s57, 16
    s_lshl_b32 s56, s56, 8
    s_add_u32 s56, s56, s57
    s_add_u32 s56, s56, 1
    v_mov_b32 v57, s56
    s_lshl_b32 s47, s56, 3
    s_mov_b64 exec, 1
    buffer_atomic_add v57, v56, s[16:19], 0 offen sc1
    s_mov_b64 exec, -1
Larr_2:
    s_waitcnt lgkmcnt(0)
    v_add_f32 v48, v48, v49
    v_add_f32 v50, v50, v51
    v_add_f32 v52, v52, v53
    v_add_f32 v54, v54, v55
    v_add_f32 v48, v48, v50
    v_add_f32 v52, v52, v54
    v_add_f32 v48, v48, v52
    v_cvt_pk_bf16_f32 v48, v48, v48
    ds_write_b16 v71, v48
    s_waitcnt lgkmcnt(0)
    s_barrier
    v_and_b32 v71, 48, v0
    v_add_u32 v71, 156992, v71
    ds_read_b128 v[16:19], v71 offset:0
    ds_read_b128 v[20:23], v71 offset:64
    ds_read_b128 v[24:27], v71 offset:128
    ds_read_b128 v[28:31], v71 offset:192
    s_waitcnt lgkmcnt(0)
    ds_read_b128 v[72:75], v6 offset:0
    ds_read_b128 v[76:79], v7 offset:0
    ds_read_b128 v[80:83], v8 offset:0
    ds_read_b128 v[84:87], v9 offset:0
    s_waitcnt lgkmcnt(0)
    v_mfma_f32_16x16x32_bf16 v[48:51], v[72:75], v[16:19], 0
    v_mfma_f32_16x16x32_bf16 v[48:51], v[76:79], v[20:23], v[48:51]
    v_mfma_f32_16x16x32_bf16 v[48:51], v[80:83], v[24:27], v[48:51]
    v_mfma_f32_16x16x32_bf16 v[48:51], v[84:87], v[28:31], v[48:51]
    s_add_u32 m0, s43, 0
    s_xor_b32 s66, s79, 1994752
    buffer_load_dwordx4 v2, s[4:7], s66 offen offset:0 nt lds
    buffer_load_dwordx4 v3, s[4:7], s66 offen offset:1024 nt lds
    buffer_load_dwordx4 v4, s[4:7], s66 offen offset:2048 nt lds
    buffer_load_dwordx4 v5, s[4:7], s66 offen offset:3072 nt lds
    ds_read_b128 v[88:91], v6 offset:4096
    ds_read_b128 v[92:95], v7 offset:4096
    ds_read_b128 v[96:99], v8 offset:4096
    ds_read_b128 v[100:103], v9 offset:4096
    s_waitcnt lgkmcnt(0)
    v_mfma_f32_16x16x32_bf16 v[52:55], v[88:91], v[16:19], 0
    v_mfma_f32_16x16x32_bf16 v[52:55], v[92:95], v[20:23], v[52:55]
    v_mfma_f32_16x16x32_bf16 v[52:55], v[96:99], v[24:27], v[52:55]
    v_mfma_f32_16x16x32_bf16 v[52:55], v[100:103], v[28:31], v[52:55]
    s_add_u32 m0, s43, 4096
    s_xor_b32 s66, s79, 1757184
    buffer_load_dwordx4 v2, s[4:7], s66 offen offset:0 nt lds
    buffer_load_dwordx4 v3, s[4:7], s66 offen offset:1024 nt lds
    buffer_load_dwordx4 v4, s[4:7], s66 offen offset:2048 nt lds
    buffer_load_dwordx4 v5, s[4:7], s66 offen offset:3072 nt lds
    ds_read_b128 v[104:107], v6 offset:8192
    ds_read_b128 v[108:111], v7 offset:8192
    ds_read_b128 v[112:115], v8 offset:8192
    ds_read_b128 v[116:119], v9 offset:8192
    s_lshl_b64 s[52:53], s[58:59], 0
    v_cndmask_b32 v56, v56, v48, s[52:53]
    v_cndmask_b32 v57, v57, v49, s[52:53]
    v_cndmask_b32 v58, v58, v50, s[52:53]
    v_cndmask_b32 v59, v59, v51, s[52:53]
    s_waitcnt lgkmcnt(0)
    v_mfma_f32_16x16x32_bf16 v[48:51], v[104:107], v[16:19], 0
    v_mfma_f32_16x16x32_bf16 v[48:51], v[108:111], v[20:23], v[48:51]
    v_mfma_f32_16x16x32_bf16 v[48:51], v[112:115], v[24:27], v[48:51]
    v_mfma_f32_16x16x32_bf16 v[48:51], v[116:119], v[28:31], v[48:51]
    s_add_u32 m0, s43, 8192
    s_xor_b32 s66, s79, 1060864
    buffer_load_dwordx4 v2, s[4:7], s66 offen offset:0 nt lds
    buffer_load_dwordx4 v3, s[4:7], s66 offen offset:1024 nt lds
    buffer_load_dwordx4 v4, s[4:7], s66 offen offset:2048 nt lds
    buffer_load_dwordx4 v5, s[4:7], s66 offen offset:3072 nt lds
    ds_read_b128 v[120:123], v6 offset:12288
    ds_read_b128 v[124:127], v7 offset:12288
    ds_read_b128 v[128:131], v8 offset:12288
    ds_read_b128 v[132:135], v9 offset:12288
    s_lshl_b64 s[52:53], s[58:59], 1
    v_cndmask_b32 v56, v56, v52, s[52:53]
    v_cndmask_b32 v57, v57, v53, s[52:53]
    v_cndmask_b32 v58, v58, v54, s[52:53]
    v_cndmask_b32 v59, v59, v55, s[52:53]
    s_waitcnt lgkmcnt(0)
    v_mfma_f32_16x16x32_bf16 v[52:55], v[120:123], v[16:19], 0
    v_mfma_f32_16x16x32_bf16 v[52:55], v[124:127], v[20:23], v[52:55]
    v_mfma_f32_16x16x32_bf16 v[52:55], v[128:131], v[24:27], v[52:55]
    v_mfma_f32_16x16x32_bf16 v[52:55], v[132:135], v[28:31], v[52:55]
    s_add_u32 m0, s43, 12288
    s_xor_b32 s66, s79, 1347584
    buffer_load_dwordx4 v2, s[4:7], s66 offen offset:0 nt lds
    buffer_load_dwordx4 v3, s[4:7], s66 offen offset:1024 nt lds
    buffer_load_dwordx4 v4, s[4:7], s66 offen offset:2048 nt lds
    buffer_load_dwordx4 v5, s[4:7], s66 offen offset:3072 nt lds
    ds_read_b128 v[136:139], v6 offset:16384
    ds_read_b128 v[140:143], v7 offset:16384
    ds_read_b128 v[144:147], v8 offset:16384
    ds_read_b128 v[148:151], v9 offset:16384
    s_lshl_b64 s[52:53], s[58:59], 2
    v_cndmask_b32 v56, v56, v48, s[52:53]
    v_cndmask_b32 v57, v57, v49, s[52:53]
    v_cndmask_b32 v58, v58, v50, s[52:53]
    v_cndmask_b32 v59, v59, v51, s[52:53]
    s_waitcnt lgkmcnt(0)
    v_mfma_f32_16x16x32_bf16 v[48:51], v[136:139], v[16:19], 0
    v_mfma_f32_16x16x32_bf16 v[48:51], v[140:143], v[20:23], v[48:51]
    v_mfma_f32_16x16x32_bf16 v[48:51], v[144:147], v[24:27], v[48:51]
    v_mfma_f32_16x16x32_bf16 v[48:51], v[148:151], v[28:31], v[48:51]
    s_add_u32 m0, s43, 16384
    s_xor_b32 s66, s79, 1961984
    buffer_load_dwordx4 v2, s[4:7], s66 offen offset:0 nt lds
    buffer_load_dwordx4 v3, s[4:7], s66 offen offset:1024 nt lds
    buffer_load_dwordx4 v4, s[4:7], s66 offen offset:2048 nt lds
    buffer_load_dwordx4 v5, s[4:7], s66 offen offset:3072 nt lds
    ds_read_b128 v[152:155], v6 offset:20480
    ds_read_b128 v[156:159], v7 offset:20480
    ds_read_b128 v[160:163], v8 offset:20480
    ds_read_b128 v[164:167], v9 offset:20480
    s_lshl_b64 s[52:53], s[58:59], 3
    v_cndmask_b32 v56, v56, v52, s[52:53]
    v_cndmask_b32 v57, v57, v53, s[52:53]
    v_cndmask_b32 v58, v58, v54, s[52:53]
    v_cndmask_b32 v59, v59, v55, s[52:53]
    s_waitcnt lgkmcnt(0)
    v_mfma_f32_16x16x32_bf16 v[52:55], v[152:155], v[16:19], 0
    v_mfma_f32_16x16x32_bf16 v[52:55], v[156:159], v[20:23], v[52:55]
    v_mfma_f32_16x16x32_bf16 v[52:55], v[160:163], v[24:27], v[52:55]
    v_mfma_f32_16x16x32_bf16 v[52:55], v[164:167], v[28:31], v[52:55]
    ds_read_b128 v[168:171], v6 offset:24576
    ds_read_b128 v[172:175], v7 offset:24576
    ds_read_b128 v[176:179], v8 offset:24576
    ds_read_b128 v[180:183], v9 offset:24576
    s_lshl_b64 s[52:53], s[58:59], 4
    v_cndmask_b32 v56, v56, v48, s[52:53]
    v_cndmask_b32 v57, v57, v49, s[52:53]
    v_cndmask_b32 v58, v58, v50, s[52:53]
    v_cndmask_b32 v59, v59, v51, s[52:53]
    s_waitcnt lgkmcnt(0)
    v_mfma_f32_16x16x32_bf16 v[48:51], v[168:171], v[16:19], 0
    v_mfma_f32_16x16x32_bf16 v[48:51], v[172:175], v[20:23], v[48:51]
    v_mfma_f32_16x16x32_bf16 v[48:51], v[176:179], v[24:27], v[48:51]
    v_mfma_f32_16x16x32_bf16 v[48:51], v[180:183], v[28:31], v[48:51]
    ds_read_b128 v[184:187], v6 offset:28672
    ds_read_b128 v[188:191], v7 offset:28672
    ds_read_b128 v[192:195], v8 offset:28672
    ds_read_b128 v[196:199], v9 offset:28672
    s_lshl_b64 s[52:53], s[58:59], 5
    v_cndmask_b32 v56, v56, v52, s[52:53]
    v_cndmask_b32 v57, v57, v53, s[52:53]
    v_cndmask_b32 v58, v58, v54, s[52:53]
    v_cndmask_b32 v59, v59, v55, s[52:53]
    s_waitcnt lgkmcnt(0)
    v_mfma_f32_16x16x32_bf16 v[52:55], v[184:187], v[16:19], 0
    v_mfma_f32_16x16x32_bf16 v[52:55], v[188:191], v[20:23], v[52:55]
    v_mfma_f32_16x16x32_bf16 v[52:55], v[192:195], v[24:27], v[52:55]
    v_mfma_f32_16x16x32_bf16 v[52:55], v[196:199], v[28:31], v[52:55]
    s_lshl_b64 s[52:53], s[58:59], 6
    v_cndmask_b32 v56, v56, v48, s[52:53]
    v_cndmask_b32 v57, v57, v49, s[52:53]
    v_cndmask_b32 v58, v58, v50, s[52:53]
    v_cndmask_b32 v59, v59, v51, s[52:53]
    s_lshl_b64 s[52:53], s[58:59], 7
s_nop 1
    v_cndmask_b32 v56, v56, v52, s[52:53]
    v_cndmask_b32 v57, v57, v53, s[52:53]
    v_cndmask_b32 v58, v58, v54, s[52:53]
    v_cndmask_b32 v59, v59, v55, s[52:53]
    v_mov_b32 v236, v56
    v_mov_b32 v237, v57
    v_mov_b32 v238, v58
    v_mov_b32 v239, v59
    v_lshlrev_b32 v48, 16, v232
    v_and_b32 v49, 0xffff0000, v232
    v_lshlrev_b32 v50, 16, v233
    v_and_b32 v51, 0xffff0000, v233
    v_lshlrev_b32 v52, 16, v234
    v_and_b32 v53, 0xffff0000, v234
    v_lshlrev_b32 v54, 16, v235
    v_and_b32 v55, 0xffff0000, v235
    v_add_f32 v68, v48, v49
    v_mul_f32 v69, v48, v48
    v_fmac_f32 v69, v49, v49
    v_add_f32 v68, v68, v50
    v_fmac_f32 v69, v50, v50
    v_add_f32 v68, v68, v51
    v_fmac_f32 v69, v51, v51
    v_add_f32 v68, v68, v52
    v_fmac_f32 v69, v52, v52
    v_add_f32 v68, v68, v53
    v_fmac_f32 v69, v53, v53
    v_add_f32 v68, v68, v54
    v_fmac_f32 v69, v54, v54
    v_add_f32 v68, v68, v55
    v_fmac_f32 v69, v55, v55
s_nop 0
    v_add_f32_dpp v68, v68, v68 row_ror:8 row_mask:0xf bank_mask:0xf
    v_add_f32_dpp v69, v69, v69 row_ror:8 row_mask:0xf bank_mask:0xf
s_nop 0
    v_add_f32_dpp v68, v68, v68 row_ror:4 row_mask:0xf bank_mask:0xf
    v_add_f32_dpp v69, v69, v69 row_ror:4 row_mask:0xf bank_mask:0xf
s_nop 0
    v_add_f32_dpp v68, v68, v68 row_ror:2 row_mask:0xf bank_mask:0xf
    v_add_f32_dpp v69, v69, v69 row_ror:2 row_mask:0xf bank_mask:0xf
s_nop 0
    v_add_f32_dpp v68, v68, v68 row_ror:1 row_mask:0xf bank_mask:0xf
    v_add_f32_dpp v69, v69, v69 row_ror:1 row_mask:0xf bank_mask:0xf
    v_mov_b32 v70, v68
    v_mov_b32 v71, v69
s_nop 0
    v_permlane16_swap_b32 v70, v68
    v_permlane16_swap_b32 v71, v69
    v_add_f32 v68, v70, v68
    v_add_f32 v69, v71, v69
    v_mov_b32 v70, v68
    v_mov_b32 v71, v69
s_nop 0
    v_permlane32_swap_b32 v70, v68
    v_permlane32_swap_b32 v71, v69
    v_add_f32 v68, v70, v68
    v_add_f32 v69, v71, v69
    v_mul_f32 v68, 0x3b000000, v68
    v_mul_f32 v69, 0x3b000000, v69
    v_fma_f32 v69, -v68, v68, v69
    v_max_f32 v69, 0, v69
    v_add_f32 v69, 0x3727c5ac, v69
    v_rsq_f32 v69, v69
    v_sub_f32 v48, v48, v68
    v_sub_f32 v49, v49, v68
    v_sub_f32 v50, v50, v68
    v_sub_f32 v51, v51, v68
    v_sub_f32 v52, v52, v68
    v_sub_f32 v53, v53, v68
    v_sub_f32 v54, v54, v68
    v_sub_f32 v55, v55, v68
    v_mul_f32 v48, v69, v48
    v_mul_f32 v49, v69, v49
    v_mul_f32 v50, v69, v50
    v_mul_f32 v51, v69, v51
    v_mul_f32 v52, v69, v52
    v_mul_f32 v53, v69, v53
    v_mul_f32 v54, v69, v54
    v_mul_f32 v55, v69, v55
    v_cvt_pk_bf16_f32 v48, v48, v48
    v_cvt_pk_bf16_f32 v49, v49, v49
    v_cvt_pk_bf16_f32 v50, v50, v50
    v_cvt_pk_bf16_f32 v51, v51, v51
    v_cvt_pk_bf16_f32 v52, v52, v52
    v_cvt_pk_bf16_f32 v53, v53, v53
    v_cvt_pk_bf16_f32 v54, v54, v54
    v_cvt_pk_bf16_f32 v55, v55, v55
    s_mul_i32 s54, s38, 1152
    s_add_u32 s54, s54, 147456
    v_and_b32 v70, 15, v0
    v_lshlrev_b32 v70, 2, v70
    v_add_u32 v70, s54, v70
    s_lshl_b32 s54, s38, 4
    s_mov_b64 s[52:53], 0xffff
    s_lshl_b64 s[52:53], s[52:53], s54
    s_mov_b64 exec, s[52:53]
    ds_write_b32 v70, v48 offset:0
    ds_write_b32 v70, v49 offset:144
    ds_write_b32 v70, v50 offset:288
    ds_write_b32 v70, v51 offset:432
    ds_write_b32 v70, v52 offset:576
    ds_write_b32 v70, v53 offset:720
    ds_write_b32 v70, v54 offset:864
    ds_write_b32 v70, v55 offset:1008
    s_mov_b64 exec, -1
    s_waitcnt lgkmcnt(0)
    ds_read_b128 v[40:43], v15 offset:0
    s_waitcnt lgkmcnt(0)
    ds_read_b128 v[44:47], v15 offset:16
    v_and_b32 v32, v40, v10
    v_and_b32 v33, v40, v11
    v_and_b32 v34, v40, v12
    v_and_b32 v35, v40, v13
    v_and_b32 v36, v41, v10
    v_and_b32 v37, v41, v11
    v_mfma_f32_16x16x32_bf16 v[60:63], a[0:3], v[32:35], 0
    v_and_b32 v38, v41, v12
    v_and_b32 v39, v41, v13
    v_mfma_f32_16x16x32_bf16 v[64:67], a[4:7], v[32:35], 0
    v_and_b32 v32, v42, v10
    v_and_b32 v33, v42, v11
    v_mfma_f32_16x16x32_bf16 v[60:63], a[8:11], v[36:39], v[60:63]
    v_and_b32 v34, v42, v12
    v_and_b32 v35, v42, v13
    v_mfma_f32_16x16x32_bf16 v[64:67], a[12:15], v[36:39], v[64:67]
    v_and_b32 v36, v43, v10
    v_and_b32 v37, v43, v11
    v_mfma_f32_16x16x32_bf16 v[60:63], a[16:19], v[32:35], v[60:63]
    v_and_b32 v38, v43, v12
    v_and_b32 v39, v43, v13
    v_mfma_f32_16x16x32_bf16 v[64:67], a[20:23], v[32:35], v[64:67]
    s_waitcnt lgkmcnt(0)
    v_and_b32 v32, v44, v10
    v_and_b32 v33, v44, v11
    v_mfma_f32_16x16x32_bf16 v[60:63], a[24:27], v[36:39], v[60:63]
    v_and_b32 v34, v44, v12
    v_and_b32 v35, v44, v13
    v_mfma_f32_16x16x32_bf16 v[64:67], a[28:31], v[36:39], v[64:67]
    ds_read_b128 v[40:43], v15 offset:32
    v_and_b32 v36, v45, v10
    v_and_b32 v37, v45, v11
    v_mfma_f32_16x16x32_bf16 v[60:63], a[32:35], v[32:35], v[60:63]
    v_and_b32 v38, v45, v12
    v_and_b32 v39, v45, v13
    v_mfma_f32_16x16x32_bf16 v[64:67], a[36:39], v[32:35], v[64:67]
    v_and_b32 v32, v46, v10
    v_and_b32 v33, v46, v11
    v_mfma_f32_16x16x32_bf16 v[60:63], a[40:43], v[36:39], v[60:63]
    v_and_b32 v34, v46, v12
    v_and_b32 v35, v46, v13
    v_mfma_f32_16x16x32_bf16 v[64:67], a[44:47], v[36:39], v[64:67]
    v_and_b32 v36, v47, v10
    v_and_b32 v37, v47, v11
    v_mfma_f32_16x16x32_bf16 v[60:63], a[48:51], v[32:35], v[60:63]
    v_and_b32 v38, v47, v12
    v_and_b32 v39, v47, v13
    v_mfma_f32_16x16x32_bf16 v[64:67], a[52:55], v[32:35], v[64:67]
    s_waitcnt lgkmcnt(0)
    v_and_b32 v32, v40, v10
    v_and_b32 v33, v40, v11
    v_mfma_f32_16x16x32_bf16 v[60:63], a[56:59], v[36:39], v[60:63]
    v_and_b32 v34, v40, v12
    v_and_b32 v35, v40, v13
    v_mfma_f32_16x16x32_bf16 v[64:67], a[60:63], v[36:39], v[64:67]
    ds_read_b128 v[44:47], v15 offset:48
    v_and_b32 v36, v41, v10
    v_and_b32 v37, v41, v11
    v_mfma_f32_16x16x32_bf16 v[60:63], a[64:67], v[32:35], v[60:63]
    v_and_b32 v38, v41, v12
    v_and_b32 v39, v41, v13
    v_mfma_f32_16x16x32_bf16 v[64:67], a[68:71], v[32:35], v[64:67]
    v_and_b32 v32, v42, v10
    v_and_b32 v33, v42, v11
    v_mfma_f32_16x16x32_bf16 v[60:63], a[72:75], v[36:39], v[60:63]
    v_and_b32 v34, v42, v12
    v_and_b32 v35, v42, v13
    v_mfma_f32_16x16x32_bf16 v[64:67], a[76:79], v[36:39], v[64:67]
    v_and_b32 v36, v43, v10
    v_and_b32 v37, v43, v11
    v_mfma_f32_16x16x32_bf16 v[60:63], a[80:83], v[32:35], v[60:63]
    v_and_b32 v38, v43, v12
    v_and_b32 v39, v43, v13
    v_mfma_f32_16x16x32_bf16 v[64:67], a[84:87], v[32:35], v[64:67]
    s_waitcnt lgkmcnt(0)
    v_and_b32 v32, v44, v10
    v_and_b32 v33, v44, v11
    v_mfma_f32_16x16x32_bf16 v[60:63], a[88:91], v[36:39], v[60:63]
    v_and_b32 v34, v44, v12
    v_and_b32 v35, v44, v13
    v_mfma_f32_16x16x32_bf16 v[64:67], a[92:95], v[36:39], v[64:67]
    v_and_b32 v36, v45, v10
    v_and_b32 v37, v45, v11
    v_mfma_f32_16x16x32_bf16 v[60:63], a[96:99], v[32:35], v[60:63]
    v_and_b32 v38, v45, v12
    v_and_b32 v39, v45, v13
    v_mfma_f32_16x16x32_bf16 v[64:67], a[100:103], v[32:35], v[64:67]
    v_and_b32 v32, v46, v10
    v_and_b32 v33, v46, v11
    v_mfma_f32_16x16x32_bf16 v[60:63], a[104:107], v[36:39], v[60:63]
    v_and_b32 v34, v46, v12
    v_and_b32 v35, v46, v13
    v_mfma_f32_16x16x32_bf16 v[64:67], a[108:111], v[36:39], v[64:67]
    v_and_b32 v36, v47, v10
    v_and_b32 v37, v47, v11
    v_mfma_f32_16x16x32_bf16 v[60:63], a[112:115], v[32:35], v[60:63]
    v_and_b32 v38, v47, v12
    v_and_b32 v39, v47, v13
    v_mfma_f32_16x16x32_bf16 v[64:67], a[116:119], v[32:35], v[64:67]
s_nop 0
    v_mfma_f32_16x16x32_bf16 v[60:63], a[120:123], v[36:39], v[60:63]
    v_mfma_f32_16x16x32_bf16 v[64:67], a[124:127], v[36:39], v[64:67]
    v_and_b32 v70, 15, v0
    v_lshrrev_b32 v71, 3, v70
    s_lshl_b32 s54, s38, 1
    v_add_u32 v71, s54, v71
    v_lshlrev_b32 v71, 9, v71
    v_and_b32 v70, 7, v70
    v_lshl_add_u32 v71, v70, 2, v71
    v_lshrrev_b32 v70, 4, v0
    v_lshl_add_u32 v71, v70, 7, v71
    v_add_u32 v71, 152064, v71
    v_cndmask_b32 v56, v64, v60, s[62:63]
    v_cndmask_b32 v57, v65, v61, s[62:63]
    v_cndmask_b32 v58, v66, v62, s[62:63]
    v_cndmask_b32 v59, v67, v63, s[62:63]
    ds_write_b32 v71, v56 offset:0
    ds_write_b32 v71, v57 offset:32
    ds_write_b32 v71, v58 offset:64
    ds_write_b32 v71, v59 offset:96
    s_and_b32 s54, s38, 1
    s_lshl_b32 s54, s54, 8
    v_lshlrev_b32 v70, 2, v0
    v_add_u32 v70, s54, v70
    v_lshrrev_b32 v71, 1, v70
    v_add_u32 v71, 160800, v71
    v_add_u32 v70, 152064, v70
    s_waitcnt lgkmcnt(0)
    s_barrier
    ds_read_b32 v48, v70 offset:0
    ds_read_b32 v49, v70 offset:512
    ds_read_b32 v50, v70 offset:1024
    ds_read_b32 v51, v70 offset:1536
    ds_read_b32 v52, v70 offset:2048
    ds_read_b32 v53, v70 offset:2560
    ds_read_b32 v54, v70 offset:3072
    ds_read_b32 v55, v70 offset:3584
    s_cmp_lg_u32 s38, 0
    s_cbranch_scc1 Larr_3
    s_branch Larr_3
    s_mov_b32 s16, s34
    s_and_b32 s17, s35, 0xffff
    s_mov_b32 s18, 256
    s_mov_b32 s19, 0x20000
    s_lshl_b32 s55, s39, 2
    v_mov_b32 v56, s55
    s_getreg_b32 s56, hwreg(HW_REG_XCC_ID, 0, 4)
    s_mul_i32 s57, s56, s56
    s_lshl_b32 s57, s57, 16
    s_lshl_b32 s56, s56, 8
    s_add_u32 s56, s56, s57
    s_add_u32 s56, s56, 1
    v_mov_b32 v57, s56
    s_lshl_b32 s47, s56, 3
    s_mov_b64 exec, 1
    buffer_atomic_add v57, v56, s[16:19], 0 offen sc1
    s_mov_b64 exec, -1
Larr_3:
    s_waitcnt lgkmcnt(0)
    v_add_f32 v48, v48, v49
    v_add_f32 v50, v50, v51
    v_add_f32 v52, v52, v53
    v_add_f32 v54, v54, v55
    v_add_f32 v48, v48, v50
    v_add_f32 v52, v52, v54
    v_add_f32 v48, v48, v52
    v_cvt_pk_bf16_f32 v48, v48, v48
    ds_write_b16 v71, v48
    s_waitcnt lgkmcnt(0)
    s_barrier
    v_mov_b32 v56, v236
    v_mov_b32 v57, v237
    v_mov_b32 v58, v238
    v_mov_b32 v59, v239
    s_waitcnt vmcnt(16)
    ds_read_b128 v[32:35], v6 offset:0
    ds_read_b128 v[36:39], v7 offset:0
    ds_read_b128 v[40:43], v8 offset:0
    ds_read_b128 v[44:47], v9 offset:0
    s_waitcnt lgkmcnt(0)
    v_mfma_f32_16x16x32_bf16 v[48:51], v[32:35], v[16:19], 0
    v_mfma_f32_16x16x32_bf16 v[48:51], v[36:39], v[20:23], v[48:51]
    v_mfma_f32_16x16x32_bf16 v[48:51], v[40:43], v[24:27], v[48:51]
    v_mfma_f32_16x16x32_bf16 v[48:51], v[44:47], v[28:31], v[48:51]
    s_add_u32 m0, s43, 20480
    s_xor_b32 s66, s79, 1658880
    buffer_load_dwordx4 v2, s[4:7], s66 offen offset:0 nt lds
    buffer_load_dwordx4 v3, s[4:7], s66 offen offset:1024 nt lds
    buffer_load_dwordx4 v4, s[4:7], s66 offen offset:2048 nt lds
    buffer_load_dwordx4 v5, s[4:7], s66 offen offset:3072 nt lds
    s_add_u32 m0, s43, 24576
    s_xor_b32 s66, s79, 1290240
    buffer_load_dwordx4 v2, s[4:7], s66 offen offset:0 nt lds
    buffer_load_dwordx4 v3, s[4:7], s66 offen offset:1024 nt lds
    buffer_load_dwordx4 v4, s[4:7], s66 offen offset:2048 nt lds
    buffer_load_dwordx4 v5, s[4:7], s66 offen offset:3072 nt lds
    s_add_u32 m0, s43, 28672
    s_xor_b32 s66, s79, 1511424
    buffer_load_dwordx4 v2, s[4:7], s66 offen offset:0 nt lds
    buffer_load_dwordx4 v3, s[4:7], s66 offen offset:1024 nt lds
    buffer_load_dwordx4 v4, s[4:7], s66 offen offset:2048 nt lds
    buffer_load_dwordx4 v5, s[4:7], s66 offen offset:3072 nt lds
    s_mov_b32 s16, s22
    s_and_b32 s17, s23, 0xffff
    s_mov_b32 s18, 4194304
    s_mov_b32 s19, 0x20000
    s_mov_b32 s55, 1024
    s_and_b32 s56, s2, 7
    s_lshl_b32 s56, s56, 19
    s_lshl_b32 s57, s38, 17
    s_add_u32 s56, s56, s57
    s_lshr_b32 s57, s2, 3
    s_lshl_b32 s57, s57, 5
    s_add_u32 s56, s56, s57
    v_lshrrev_b32 v70, 1, v0
    v_mul_lo_u32 v70, v70, s55
    v_and_b32 v71, 1, v0
    v_lshl_add_u32 v70, v71, 4, v70
    s_lshl_b32 s57, s55, 5
    s_add_u32 m0, s44, 0
s_nop 0
    buffer_load_dwordx4 v70, s[16:19], s56 offen lds
    s_add_u32 m0, s44, 1024
    s_add_u32 s56, s56, s57
    buffer_load_dwordx4 v70, s[16:19], s56 offen lds
    s_add_u32 m0, s44, 2048
    s_add_u32 s56, s56, s57
    buffer_load_dwordx4 v70, s[16:19], s56 offen lds
    s_add_u32 m0, s44, 3072
    s_add_u32 s56, s56, s57
    buffer_load_dwordx4 v70, s[16:19], s56 offen lds
    s_xor_b32 s67, s79, 1290240
    buffer_load_dwordx4 a[224:227], v1, s[8:11], s67 offen offset:0 nt
    buffer_load_dwordx4 a[228:231], v1, s[8:11], s67 offen offset:1024 nt
    buffer_load_dwordx4 a[232:235], v1, s[8:11], s67 offen offset:2048 nt
    buffer_load_dwordx4 a[236:239], v1, s[8:11], s67 offen offset:3072 nt
    s_xor_b32 s67, s79, 1511424
    buffer_load_dwordx4 a[240:243], v1, s[8:11], s67 offen offset:0 nt
    buffer_load_dwordx4 a[244:247], v1, s[8:11], s67 offen offset:1024 nt
    buffer_load_dwordx4 a[248:251], v1, s[8:11], s67 offen offset:2048 nt
    buffer_load_dwordx4 a[252:255], v1, s[8:11], s67 offen offset:3072 nt
    s_xor_b32 s67, s79, 0
    buffer_load_dwordx4 a[0:3], v1, s[8:11], s67 offen offset:0 nt
    buffer_load_dwordx4 a[4:7], v1, s[8:11], s67 offen offset:1024 nt
    buffer_load_dwordx4 a[8:11], v1, s[8:11], s67 offen offset:2048 nt
    buffer_load_dwordx4 a[12:15], v1, s[8:11], s67 offen offset:3072 nt
    s_waitcnt vmcnt(40)
    ds_read_b128 v[32:35], v6 offset:4096
    ds_read_b128 v[36:39], v7 offset:4096
    ds_read_b128 v[40:43], v8 offset:4096
    ds_read_b128 v[44:47], v9 offset:4096
    s_waitcnt lgkmcnt(0)
    v_mfma_f32_16x16x32_bf16 v[52:55], v[32:35], v[16:19], 0
    v_mfma_f32_16x16x32_bf16 v[52:55], v[36:39], v[20:23], v[52:55]
    v_mfma_f32_16x16x32_bf16 v[52:55], v[40:43], v[24:27], v[52:55]
    v_mfma_f32_16x16x32_bf16 v[52:55], v[44:47], v[28:31], v[52:55]
    s_xor_b32 s67, s79, 303104
    buffer_load_dwordx4 a[16:19], v1, s[8:11], s67 offen offset:0 nt
    buffer_load_dwordx4 a[20:23], v1, s[8:11], s67 offen offset:1024 nt
    buffer_load_dwordx4 a[24:27], v1, s[8:11], s67 offen offset:2048 nt
    buffer_load_dwordx4 a[28:31], v1, s[8:11], s67 offen offset:3072 nt
    s_waitcnt vmcnt(40)
    ds_read_b128 v[32:35], v6 offset:8192
    ds_read_b128 v[36:39], v7 offset:8192
    ds_read_b128 v[40:43], v8 offset:8192
    ds_read_b128 v[44:47], v9 offset:8192
    s_lshl_b64 s[52:53], s[58:59], 8
    v_cndmask_b32 v56, v56, v48, s[52:53]
    v_cndmask_b32 v57, v57, v49, s[52:53]
    v_cndmask_b32 v58, v58, v50, s[52:53]
    v_cndmask_b32 v59, v59, v51, s[52:53]
    s_waitcnt lgkmcnt(0)
    v_mfma_f32_16x16x32_bf16 v[48:51], v[32:35], v[16:19], 0
    v_mfma_f32_16x16x32_bf16 v[48:51], v[36:39], v[20:23], v[48:51]
    v_mfma_f32_16x16x32_bf16 v[48:51], v[40:43], v[24:27], v[48:51]
    v_mfma_f32_16x16x32_bf16 v[48:51], v[44:47], v[28:31], v[48:51]
    s_xor_b32 s67, s79, 933888
    buffer_load_dwordx4 a[32:35], v1, s[8:11], s67 offen offset:0 nt
    buffer_load_dwordx4 a[36:39], v1, s[8:11], s67 offen offset:1024 nt
    buffer_load_dwordx4 a[40:43], v1, s[8:11], s67 offen offset:2048 nt
    buffer_load_dwordx4 a[44:47], v1, s[8:11], s67 offen offset:3072 nt
    s_waitcnt vmcnt(40)
    ds_read_b128 v[32:35], v6 offset:12288
    ds_read_b128 v[36:39], v7 offset:12288
    ds_read_b128 v[40:43], v8 offset:12288
    ds_read_b128 v[44:47], v9 offset:12288
    s_lshl_b64 s[52:53], s[58:59], 9
    v_cndmask_b32 v56, v56, v52, s[52:53]
    v_cndmask_b32 v57, v57, v53, s[52:53]
    v_cndmask_b32 v58, v58, v54, s[52:53]
    v_cndmask_b32 v59, v59, v55, s[52:53]
    s_waitcnt lgkmcnt(0)
    v_mfma_f32_16x16x32_bf16 v[52:55], v[32:35], v[16:19], 0
    v_mfma_f32_16x16x32_bf16 v[52:55], v[36:39], v[20:23], v[52:55]
    v_mfma_f32_16x16x32_bf16 v[52:55], v[40:43], v[24:27], v[52:55]
    v_mfma_f32_16x16x32_bf16 v[52:55], v[44:47], v[28:31], v[52:55]
    s_xor_b32 s67, s79, 712704
    buffer_load_dwordx4 a[48:51], v1, s[8:11], s67 offen offset:0 nt
    buffer_load_dwordx4 a[52:55], v1, s[8:11], s67 offen offset:1024 nt
    buffer_load_dwordx4 a[56:59], v1, s[8:11], s67 offen offset:2048 nt
    buffer_load_dwordx4 a[60:63], v1, s[8:11], s67 offen offset:3072 nt
    s_waitcnt vmcnt(40)
    ds_read_b128 v[32:35], v6 offset:16384
    ds_read_b128 v[36:39], v7 offset:16384
    ds_read_b128 v[40:43], v8 offset:16384
    ds_read_b128 v[44:47], v9 offset:16384
    s_lshl_b64 s[52:53], s[58:59], 10
    v_cndmask_b32 v56, v56, v48, s[52:53]
    v_cndmask_b32 v57, v57, v49, s[52:53]
    v_cndmask_b32 v58, v58, v50, s[52:53]
    v_cndmask_b32 v59, v59, v51, s[52:53]
    s_waitcnt lgkmcnt(0)
    v_mfma_f32_16x16x32_bf16 v[48:51], v[32:35], v[16:19], 0
    v_mfma_f32_16x16x32_bf16 v[48:51], v[36:39], v[20:23], v[48:51]
    v_mfma_f32_16x16x32_bf16 v[48:51], v[40:43], v[24:27], v[48:51]
    v_mfma_f32_16x16x32_bf16 v[48:51], v[44:47], v[28:31], v[48:51]
    s_xor_b32 s67, s79, 229376
    buffer_load_dwordx4 a[64:67], v1, s[8:11], s67 offen offset:0 nt
    buffer_load_dwordx4 a[68:71], v1, s[8:11], s67 offen offset:1024 nt
    buffer_load_dwordx4 a[72:75], v1, s[8:11], s67 offen offset:2048 nt
    buffer_load_dwordx4 a[76:79], v1, s[8:11], s67 offen offset:3072 nt
    s_waitcnt vmcnt(40)
    ds_read_b128 v[32:35], v6 offset:20480
    ds_read_b128 v[36:39], v7 offset:20480
    ds_read_b128 v[40:43], v8 offset:20480
    ds_read_b128 v[44:47], v9 offset:20480
    s_lshl_b64 s[52:53], s[58:59], 11
    v_cndmask_b32 v56, v56, v52, s[52:53]
    v_cndmask_b32 v57, v57, v53, s[52:53]
    v_cndmask_b32 v58, v58, v54, s[52:53]
    v_cndmask_b32 v59, v59, v55, s[52:53]
    s_waitcnt lgkmcnt(0)
    v_mfma_f32_16x16x32_bf16 v[52:55], v[32:35], v[16:19], 0
    v_mfma_f32_16x16x32_bf16 v[52:55], v[36:39], v[20:23], v[52:55]
    v_mfma_f32_16x16x32_bf16 v[52:55], v[40:43], v[24:27], v[52:55]
    v_mfma_f32_16x16x32_bf16 v[52:55], v[44:47], v[28:31], v[52:55]
    s_xor_b32 s67, s79, 466944
    buffer_load_dwordx4 a[80:83], v1, s[8:11], s67 offen offset:0 nt
    buffer_load_dwordx4 a[84:87], v1, s[8:11], s67 offen offset:1024 nt
    buffer_load_dwordx4 a[88:91], v1, s[8:11], s67 offen offset:2048 nt
    buffer_load_dwordx4 a[92:95], v1, s[8:11], s67 offen offset:3072 nt
    s_waitcnt vmcnt(40)
    ds_read_b128 v[32:35], v6 offset:24576
    ds_read_b128 v[36:39], v7 offset:24576
    ds_read_b128 v[40:43], v8 offset:24576
    ds_read_b128 v[44:47], v9 offset:24576
    s_lshl_b64 s[52:53], s[58:59], 12
    v_cndmask_b32 v56, v56, v48, s[52:53]
    v_cndmask_b32 v57, v57, v49, s[52:53]
    v_cndmask_b32 v58, v58, v50, s[52:53]
    v_cndmask_b32 v59, v59, v51, s[52:53]
    s_waitcnt lgkmcnt(0)
    v_mfma_f32_16x16x32_bf16 v[48:51], v[32:35], v[16:19], 0
    v_mfma_f32_16x16x32_bf16 v[48:51], v[36:39], v[20:23], v[48:51]
    v_mfma_f32_16x16x32_bf16 v[48:51], v[40:43], v[24:27], v[48:51]
    v_mfma_f32_16x16x32_bf16 v[48:51], v[44:47], v[28:31], v[48:51]
    s_xor_b32 s67, s79, 901120
    buffer_load_dwordx4 a[96:99], v1, s[8:11], s67 offen offset:0 nt
    buffer_load_dwordx4 a[100:103], v1, s[8:11], s67 offen offset:1024 nt
    buffer_load_dwordx4 a[104:107], v1, s[8:11], s67 offen offset:2048 nt
    buffer_load_dwordx4 a[108:111], v1, s[8:11], s67 offen offset:3072 nt
    s_waitcnt vmcnt(40)
    ds_read_b128 v[32:35], v6 offset:28672
    ds_read_b128 v[36:39], v7 offset:28672
    ds_read_b128 v[40:43], v8 offset:28672
    ds_read_b128 v[44:47], v9 offset:28672
    s_lshl_b64 s[52:53], s[58:59], 13
    v_cndmask_b32 v56, v56, v52, s[52:53]
    v_cndmask_b32 v57, v57, v53, s[52:53]
    v_cndmask_b32 v58, v58, v54, s[52:53]
    v_cndmask_b32 v59, v59, v55, s[52:53]
    s_waitcnt lgkmcnt(0)
    v_mfma_f32_16x16x32_bf16 v[52:55], v[32:35], v[16:19], 0
    v_mfma_f32_16x16x32_bf16 v[52:55], v[36:39], v[20:23], v[52:55]
    v_mfma_f32_16x16x32_bf16 v[52:55], v[40:43], v[24:27], v[52:55]
    v_mfma_f32_16x16x32_bf16 v[52:55], v[44:47], v[28:31], v[52:55]
    s_xor_b32 s67, s79, 614400
    buffer_load_dwordx4 a[112:115], v1, s[8:11], s67 offen offset:0 nt
    buffer_load_dwordx4 a[116:119], v1, s[8:11], s67 offen offset:1024 nt
    buffer_load_dwordx4 a[120:123], v1, s[8:11], s67 offen offset:2048 nt
    buffer_load_dwordx4 a[124:127], v1, s[8:11], s67 offen offset:3072 nt
    s_lshl_b64 s[52:53], s[58:59], 14
    v_cndmask_b32 v56, v56, v48, s[52:53]
    v_cndmask_b32 v57, v57, v49, s[52:53]
    v_cndmask_b32 v58, v58, v50, s[52:53]
    v_cndmask_b32 v59, v59, v51, s[52:53]
    s_lshl_b64 s[52:53], s[58:59], 15
    v_cndmask_b32 v56, v56, v52, s[52:53]
    v_cndmask_b32 v57, v57, v53, s[52:53]
    v_cndmask_b32 v58, v58, v54, s[52:53]
    v_cndmask_b32 v59, v59, v55, s[52:53]
    v_max3_f32 v70, v56, v57, v58
    v_max_f32 v70, v70, v59
s_nop 1
    v_max_f32_dpp v70, v70, v70 row_ror:8 row_mask:0xf bank_mask:0xf
s_nop 1
    v_max_f32_dpp v70, v70, v70 row_ror:4 row_mask:0xf bank_mask:0xf
s_nop 1
    v_max_f32_dpp v70, v70, v70 row_ror:2 row_mask:0xf bank_mask:0xf
s_nop 1
    v_max_f32_dpp v70, v70, v70 row_ror:1 row_mask:0xf bank_mask:0xf
    v_mov_b32 v71, v70
s_nop 1
    v_permlane16_swap_b32 v71, v70
    v_max_f32 v70, v71, v70
    v_mov_b32 v71, v70
s_nop 1
    v_permlane32_swap_b32 v71, v70
    v_max_f32 v70, v71, v70
    v_mov_b32 v68, v70
    v_mul_f32 v70, s60, v68
    v_fma_f32 v56, v56, s60, -v70
    v_fma_f32 v57, v57, s60, -v70
    v_fma_f32 v58, v58, s60, -v70
    v_fma_f32 v59, v59, s60, -v70
    v_exp_f32 v56, v56
    v_exp_f32 v57, v57
    v_exp_f32 v58, v58
    v_exp_f32 v59, v59
    v_cvt_pk_bf16_f32 v48, v56, v56
    v_cvt_pk_bf16_f32 v49, v57, v57
    v_cvt_pk_bf16_f32 v50, v58, v58
    v_cvt_pk_bf16_f32 v51, v59, v59
    ds_write_b32 v14, v48 offset:0
    ds_write_b32 v14, v49 offset:144
    ds_write_b32 v14, v50 offset:288
    ds_write_b32 v14, v51 offset:432
    v_add_f32 v56, v56, v57
    v_add_f32 v58, v58, v59
    v_add_f32 v56, v56, v58
    v_mov_b32 v69, v56
    s_waitcnt lgkmcnt(0)
    ds_read_b128 v[40:43], v15 offset:64
    s_waitcnt lgkmcnt(0)
    ds_read_b128 v[44:47], v15 offset:80
    v_and_b32 v32, v40, v10
    v_and_b32 v33, v40, v11
    v_and_b32 v34, v40, v12
    v_and_b32 v35, v40, v13
    s_cmp_lg_u32 s38, 0
    s_cbranch_scc1 Lal_4
    s_mov_b32 s16, s34
    s_and_b32 s17, s35, 0xffff
    s_mov_b32 s18, 256
    s_mov_b32 s19, 0x20000
    v_and_b32 v57, 31, v0
    v_lshlrev_b32 v57, 2, v57
    buffer_load_dword v56, v57, s[16:19], 0 offen sc1
Lal_4:
    s_waitcnt vmcnt(40)
    v_lshrrev_b32 v70, 4, v0
    v_lshlrev_b32 v70, 3, v70
    v_bfe_u32 v71, v0, 2, 2
    v_add_u32 v70, v70, v71
    v_lshlrev_b32 v70, 5, v70
    v_and_b32 v71, 3, v0
    v_lshl_add_u32 v70, v71, 3, v70
    v_add_u32 v70, s44, v70
    ds_read_b64_tr_b16 v[16:17], v70 offset:0
    ds_read_b64_tr_b16 v[18:19], v70 offset:128
    ds_read_b64_tr_b16 v[20:21], v70 offset:1024
    ds_read_b64_tr_b16 v[22:23], v70 offset:1152
    ds_read_b64_tr_b16 v[24:25], v70 offset:2048
    ds_read_b64_tr_b16 v[26:27], v70 offset:2176
    ds_read_b64_tr_b16 v[28:29], v70 offset:3072
    ds_read_b64_tr_b16 v[30:31], v70 offset:3200
    v_add_f32_dpp v69, v69, v69 row_ror:8 row_mask:0xf bank_mask:0xf
s_nop 1
    v_add_f32_dpp v69, v69, v69 row_ror:4 row_mask:0xf bank_mask:0xf
s_nop 1
    v_add_f32_dpp v69, v69, v69 row_ror:2 row_mask:0xf bank_mask:0xf
s_nop 1
    v_add_f32_dpp v69, v69, v69 row_ror:1 row_mask:0xf bank_mask:0xf
    v_mov_b32 v70, v69
s_nop 1
    v_permlane16_swap_b32 v70, v69
    v_add_f32 v69, v70, v69
    v_mov_b32 v70, v69
s_nop 1
    v_permlane32_swap_b32 v70, v69
    v_add_f32 v69, v70, v69
    s_lshl_b32 s54, s38, 3
    s_add_u32 s54, s54, 156160
    v_mov_b32 v70, s54
    ds_write_b64 v70, v[68:69]
    s_waitcnt lgkmcnt(0)
    s_cmp_lt_u32 s2, 112
    s_cbranch_scc1 Ls2_5
    s_mov_b32 s16, s20
    s_and_b32 s17, s21, 0xffff
    s_mov_b32 s18, 4194304
    s_mov_b32 s19, 0x20000
    s_mov_b32 s55, 8192
    s_lshr_b32 s56, s40, 1
    s_lshl_b32 s56, s56, 20
    s_lshl_b32 s57, s39, 8
    s_add_u32 s56, s56, s57
    s_and_b32 s57, s40, 1
    s_lshl_b32 s57, s57, 7
    s_add_u32 s56, s56, s57
    s_lshl_b32 s57, s38, 5
    s_add_u32 s56, s56, s57
    s_branch Ls2j_6
Ls2_5:
    s_mov_b32 s16, s24
    s_and_b32 s17, s25, 0xffff
    s_mov_b32 s18, 1835008
    s_mov_b32 s19, 0x20000
    s_mov_b32 s55, 3584
    s_mul_i32 s56, s38, 458752
    s_lshl_b32 s57, s2, 5
    s_add_u32 s56, s56, s57
Ls2j_6:
    v_lshrrev_b32 v70, 1, v0
    v_mul_lo_u32 v70, v70, s55
    v_and_b32 v71, 1, v0
    v_lshl_add_u32 v70, v71, 4, v70
    s_lshl_b32 s57, s55, 5
    s_add_u32 m0, s44, 0
s_nop 0
    buffer_load_dwordx4 v70, s[16:19], s56 offen lds
    s_add_u32 m0, s44, 1024
    s_add_u32 s56, s56, s57
    buffer_load_dwordx4 v70, s[16:19], s56 offen lds
    s_add_u32 m0, s44, 2048
    s_add_u32 s56, s56, s57
    buffer_load_dwordx4 v70, s[16:19], s56 offen lds
    s_add_u32 m0, s44, 3072
    s_add_u32 s56, s56, s57
    buffer_load_dwordx4 v70, s[16:19], s56 offen lds
    v_and_b32 v36, v41, v10
    v_and_b32 v37, v41, v11
    v_mfma_f32_16x16x32_bf16 v[60:63], a[128:131], v[32:35], 0
    v_and_b32 v38, v41, v12
    v_and_b32 v39, v41, v13
    v_mfma_f32_16x16x32_bf16 v[64:67], a[132:135], v[32:35], 0
    v_and_b32 v32, v42, v10
    v_and_b32 v33, v42, v11
    v_mfma_f32_16x16x32_bf16 v[60:63], a[136:139], v[36:39], v[60:63]
    v_and_b32 v34, v42, v12
    v_and_b32 v35, v42, v13
    v_mfma_f32_16x16x32_bf16 v[64:67], a[140:143], v[36:39], v[64:67]
    v_and_b32 v36, v43, v10
    v_and_b32 v37, v43, v11
    v_mfma_f32_16x16x32_bf16 v[60:63], a[144:147], v[32:35], v[60:63]
    v_and_b32 v38, v43, v12
    v_and_b32 v39, v43, v13
    v_mfma_f32_16x16x32_bf16 v[64:67], a[148:151], v[32:35], v[64:67]
    s_waitcnt lgkmcnt(9)
    v_and_b32 v32, v44, v10
    v_and_b32 v33, v44, v11
    v_mfma_f32_16x16x32_bf16 v[60:63], a[152:155], v[36:39], v[60:63]
    v_and_b32 v34, v44, v12
    v_and_b32 v35, v44, v13
    v_mfma_f32_16x16x32_bf16 v[64:67], a[156:159], v[36:39], v[64:67]
    ds_read_b128 v[40:43], v15 offset:96
    v_and_b32 v36, v45, v10
    v_and_b32 v37, v45, v11
    v_mfma_f32_16x16x32_bf16 v[60:63], a[160:163], v[32:35], v[60:63]
    v_and_b32 v38, v45, v12
    v_and_b32 v39, v45, v13
    v_mfma_f32_16x16x32_bf16 v[64:67], a[164:167], v[32:35], v[64:67]
    v_and_b32 v32, v46, v10
    v_and_b32 v33, v46, v11
    v_mfma_f32_16x16x32_bf16 v[60:63], a[168:171], v[36:39], v[60:63]
    v_and_b32 v34, v46, v12
    v_and_b32 v35, v46, v13
    v_mfma_f32_16x16x32_bf16 v[64:67], a[172:175], v[36:39], v[64:67]
    v_and_b32 v36, v47, v10
    v_and_b32 v37, v47, v11
    v_mfma_f32_16x16x32_bf16 v[60:63], a[176:179], v[32:35], v[60:63]
    v_and_b32 v38, v47, v12
    v_and_b32 v39, v47, v13
    v_mfma_f32_16x16x32_bf16 v[64:67], a[180:183], v[32:35], v[64:67]
    s_waitcnt lgkmcnt(0)
    v_and_b32 v32, v40, v10
    v_and_b32 v33, v40, v11
    v_mfma_f32_16x16x32_bf16 v[60:63], a[184:187], v[36:39], v[60:63]
    v_and_b32 v34, v40, v12
    v_and_b32 v35, v40, v13
    v_mfma_f32_16x16x32_bf16 v[64:67], a[188:191], v[36:39], v[64:67]
    ds_read_b128 v[44:47], v15 offset:112
    v_and_b32 v36, v41, v10
    v_and_b32 v37, v41, v11
    v_mfma_f32_16x16x32_bf16 v[60:63], a[192:195], v[32:35], v[60:63]
    v_and_b32 v38, v41, v12
    v_and_b32 v39, v41, v13
    v_mfma_f32_16x16x32_bf16 v[64:67], a[196:199], v[32:35], v[64:67]
    v_and_b32 v32, v42, v10
    v_and_b32 v33, v42, v11
    v_mfma_f32_16x16x32_bf16 v[60:63], a[200:203], v[36:39], v[60:63]
    v_and_b32 v34, v42, v12
    v_and_b32 v35, v42, v13
    v_mfma_f32_16x16x32_bf16 v[64:67], a[204:207], v[36:39], v[64:67]
    v_and_b32 v36, v43, v10
    v_and_b32 v37, v43, v11
    v_mfma_f32_16x16x32_bf16 v[60:63], a[208:211], v[32:35], v[60:63]
    v_and_b32 v38, v43, v12
    v_and_b32 v39, v43, v13
    v_mfma_f32_16x16x32_bf16 v[64:67], a[212:215], v[32:35], v[64:67]
    s_waitcnt lgkmcnt(0)
    v_and_b32 v32, v44, v10
    v_and_b32 v33, v44, v11
    v_mfma_f32_16x16x32_bf16 v[60:63], a[216:219], v[36:39], v[60:63]
    v_and_b32 v34, v44, v12
    v_and_b32 v35, v44, v13
    v_mfma_f32_16x16x32_bf16 v[64:67], a[220:223], v[36:39], v[64:67]
    ds_read_b128 v[40:43], v15 offset:0
    s_waitcnt vmcnt(43)
    v_and_b32 v36, v45, v10
    v_and_b32 v37, v45, v11
    v_mfma_f32_16x16x32_bf16 v[60:63], a[224:227], v[32:35], v[60:63]
    s_waitcnt vmcnt(42)
    v_and_b32 v38, v45, v12
    v_and_b32 v39, v45, v13
    v_mfma_f32_16x16x32_bf16 v[64:67], a[228:231], v[32:35], v[64:67]
    s_waitcnt vmcnt(41)
    v_and_b32 v32, v46, v10
    v_and_b32 v33, v46, v11
    v_mfma_f32_16x16x32_bf16 v[60:63], a[232:235], v[36:39], v[60:63]
    s_waitcnt vmcnt(40)
    v_and_b32 v34, v46, v12
    v_and_b32 v35, v46, v13
    v_mfma_f32_16x16x32_bf16 v[64:67], a[236:239], v[36:39], v[64:67]
    s_waitcnt vmcnt(39)
    v_and_b32 v36, v47, v10
    v_and_b32 v37, v47, v11
    v_mfma_f32_16x16x32_bf16 v[60:63], a[240:243], v[32:35], v[60:63]
    s_waitcnt vmcnt(38)
    v_and_b32 v38, v47, v12
    v_and_b32 v39, v47, v13
    v_mfma_f32_16x16x32_bf16 v[64:67], a[244:247], v[32:35], v[64:67]
    s_waitcnt lgkmcnt(0)
    s_waitcnt vmcnt(37)
    v_and_b32 v32, v40, v10
    v_and_b32 v33, v40, v11
    v_mfma_f32_16x16x32_bf16 v[60:63], a[248:251], v[36:39], v[60:63]
    s_waitcnt vmcnt(36)
    v_and_b32 v34, v40, v12
    v_and_b32 v35, v40, v13
    v_mfma_f32_16x16x32_bf16 v[64:67], a[252:255], v[36:39], v[64:67]
    ds_read_b128 v[44:47], v15 offset:16
    s_waitcnt vmcnt(35)
    v_and_b32 v36, v41, v10
    v_and_b32 v37, v41, v11
    v_mfma_f32_16x16x32_bf16 v[60:63], a[0:3], v[32:35], v[60:63]
    s_waitcnt vmcnt(34)
    v_and_b32 v38, v41, v12
    v_and_b32 v39, v41, v13
    v_mfma_f32_16x16x32_bf16 v[64:67], a[4:7], v[32:35], v[64:67]
    s_waitcnt vmcnt(33)
    v_and_b32 v32, v42, v10
    v_and_b32 v33, v42, v11
    v_mfma_f32_16x16x32_bf16 v[60:63], a[8:11], v[36:39], v[60:63]
    s_waitcnt vmcnt(32)
    v_and_b32 v34, v42, v12
    v_and_b32 v35, v42, v13
    v_mfma_f32_16x16x32_bf16 v[64:67], a[12:15], v[36:39], v[64:67]
    s_waitcnt vmcnt(31)
    v_and_b32 v36, v43, v10
    v_and_b32 v37, v43, v11
    v_mfma_f32_16x16x32_bf16 v[60:63], a[16:19], v[32:35], v[60:63]
    s_waitcnt vmcnt(30)
    v_and_b32 v38, v43, v12
    v_and_b32 v39, v43, v13
    v_mfma_f32_16x16x32_bf16 v[64:67], a[20:23], v[32:35], v[64:67]
    s_waitcnt lgkmcnt(0)
    s_waitcnt vmcnt(29)
    v_and_b32 v32, v44, v10
    v_and_b32 v33, v44, v11
    v_mfma_f32_16x16x32_bf16 v[60:63], a[24:27], v[36:39], v[60:63]
    s_waitcnt vmcnt(28)
    v_and_b32 v34, v44, v12
    v_and_b32 v35, v44, v13
    v_mfma_f32_16x16x32_bf16 v[64:67], a[28:31], v[36:39], v[64:67]
    ds_read_b128 v[40:43], v15 offset:32
    s_waitcnt vmcnt(27)
    v_and_b32 v36, v45, v10
    v_and_b32 v37, v45, v11
    v_mfma_f32_16x16x32_bf16 v[60:63], a[32:35], v[32:35], v[60:63]
    s_waitcnt vmcnt(26)
    v_and_b32 v38, v45, v12
    v_and_b32 v39, v45, v13
    v_mfma_f32_16x16x32_bf16 v[64:67], a[36:39], v[32:35], v[64:67]
    s_waitcnt vmcnt(25)
    v_and_b32 v32, v46, v10
    v_and_b32 v33, v46, v11
    v_mfma_f32_16x16x32_bf16 v[60:63], a[40:43], v[36:39], v[60:63]
    s_waitcnt vmcnt(24)
    v_and_b32 v34, v46, v12
    v_and_b32 v35, v46, v13
    v_mfma_f32_16x16x32_bf16 v[64:67], a[44:47], v[36:39], v[64:67]
    s_waitcnt vmcnt(23)
    v_and_b32 v36, v47, v10
    v_and_b32 v37, v47, v11
    v_mfma_f32_16x16x32_bf16 v[60:63], a[48:51], v[32:35], v[60:63]
    s_waitcnt vmcnt(22)
    v_and_b32 v38, v47, v12
    v_and_b32 v39, v47, v13
    v_mfma_f32_16x16x32_bf16 v[64:67], a[52:55], v[32:35], v[64:67]
    s_waitcnt lgkmcnt(0)
    s_waitcnt vmcnt(21)
    v_and_b32 v32, v40, v10
    v_and_b32 v33, v40, v11
    v_mfma_f32_16x16x32_bf16 v[60:63], a[56:59], v[36:39], v[60:63]
    s_waitcnt vmcnt(20)
    v_and_b32 v34, v40, v12
    v_and_b32 v35, v40, v13
    v_mfma_f32_16x16x32_bf16 v[64:67], a[60:63], v[36:39], v[64:67]
    ds_read_b128 v[44:47], v15 offset:48
    s_waitcnt vmcnt(19)
    v_and_b32 v36, v41, v10
    v_and_b32 v37, v41, v11
    v_mfma_f32_16x16x32_bf16 v[60:63], a[64:67], v[32:35], v[60:63]
    s_waitcnt vmcnt(18)
    v_and_b32 v38, v41, v12
    v_and_b32 v39, v41, v13
    v_mfma_f32_16x16x32_bf16 v[64:67], a[68:71], v[32:35], v[64:67]
    s_waitcnt vmcnt(17)
    v_and_b32 v32, v42, v10
    v_and_b32 v33, v42, v11
    v_mfma_f32_16x16x32_bf16 v[60:63], a[72:75], v[36:39], v[60:63]
    s_waitcnt vmcnt(16)
    v_and_b32 v34, v42, v12
    v_and_b32 v35, v42, v13
    v_mfma_f32_16x16x32_bf16 v[64:67], a[76:79], v[36:39], v[64:67]
    s_waitcnt vmcnt(15)
    v_and_b32 v36, v43, v10
    v_and_b32 v37, v43, v11
    v_mfma_f32_16x16x32_bf16 v[60:63], a[80:83], v[32:35], v[60:63]
    s_waitcnt vmcnt(14)
    v_and_b32 v38, v43, v12
    v_and_b32 v39, v43, v13
    v_mfma_f32_16x16x32_bf16 v[64:67], a[84:87], v[32:35], v[64:67]
    s_waitcnt lgkmcnt(0)
    s_waitcnt vmcnt(13)
    v_and_b32 v32, v44, v10
    v_and_b32 v33, v44, v11
    v_mfma_f32_16x16x32_bf16 v[60:63], a[88:91], v[36:39], v[60:63]
    s_waitcnt vmcnt(12)
    v_and_b32 v34, v44, v12
    v_and_b32 v35, v44, v13
    v_mfma_f32_16x16x32_bf16 v[64:67], a[92:95], v[36:39], v[64:67]
    s_waitcnt vmcnt(11)
    v_and_b32 v36, v45, v10
    v_and_b32 v37, v45, v11
    v_mfma_f32_16x16x32_bf16 v[60:63], a[96:99], v[32:35], v[60:63]
    s_waitcnt vmcnt(10)
    v_and_b32 v38, v45, v12
    v_and_b32 v39, v45, v13
    v_mfma_f32_16x16x32_bf16 v[64:67], a[100:103], v[32:35], v[64:67]
    s_waitcnt vmcnt(9)
    v_and_b32 v32, v46, v10
    v_and_b32 v33, v46, v11
    v_mfma_f32_16x16x32_bf16 v[60:63], a[104:107], v[36:39], v[60:63]
    s_waitcnt vmcnt(8)
    v_and_b32 v34, v46, v12
    v_and_b32 v35, v46, v13
    v_mfma_f32_16x16x32_bf16 v[64:67], a[108:111], v[36:39], v[64:67]
    s_waitcnt vmcnt(7)
    v_and_b32 v36, v47, v10
    v_and_b32 v37, v47, v11
    v_mfma_f32_16x16x32_bf16 v[60:63], a[112:115], v[32:35], v[60:63]
    s_waitcnt vmcnt(6)
    v_and_b32 v38, v47, v12
    v_and_b32 v39, v47, v13
    v_mfma_f32_16x16x32_bf16 v[64:67], a[116:119], v[32:35], v[64:67]
    s_waitcnt vmcnt(5)
    v_mfma_f32_16x16x32_bf16 v[60:63], a[120:123], v[36:39], v[60:63]
    s_waitcnt vmcnt(4)
    v_mfma_f32_16x16x32_bf16 v[64:67], a[124:127], v[36:39], v[64:67]
    s_cmp_lg_u32 s38, 0
    s_cbranch_scc1 Lac_7
    s_waitcnt vmcnt(0)
    v_and_b32 v58, 0xff, v56
    v_cmp_gt_u32 vcc, 8, v58
    s_cbranch_vccz Lac2_8
    s_mov_b32 s16, s34
    s_and_b32 s17, s35, 0xffff
    s_mov_b32 s18, 256
    s_mov_b32 s19, 0x20000
    s_mov_b32 s48, 200000
Lpoll_9:
    buffer_load_dword v56, v57, s[16:19], 0 offen sc1
    s_waitcnt vmcnt(0)
    v_and_b32 v58, 0xff, v56
    v_cmp_gt_u32 vcc, 8, v58
    s_cbranch_vccz Lok_10
    s_sub_u32 s48, s48, 1
    s_cmp_lg_u32 s48, 0
    s_cbranch_scc1 Lpoll_9
Lok_10:
Lac2_8:
    v_cmp_eq_u32 vcc, s47, v56
    s_and_b32 s54, s39, 28
    s_lshr_b32 s54, vcc_lo, s54
    s_and_b32 s54, s54, 15
    s_cmp_eq_u32 s54, 15
    s_cselect_b32 s54, 1, 0
    v_mov_b32 v58, 160784
    v_mov_b32 v59, s54
    ds_write_b32 v58, v59
Lac_7:
    s_branch L_TAIL
L_QE:
    s_barrier
    v_and_b32 v70, 15, v0
    v_min_u32 v71, 2, v70
    v_lshlrev_b32 v71, 8, v71
    v_and_b32 v60, 48, v0
    v_add_u32 v71, v71, v60
    v_add_u32 v71, 156224, v71
    v_lshlrev_b32 v70, 8, v70
    v_add_u32 v70, v70, v60
    ds_read_b128 v[48:51], v71 offset:0
    ds_read_b128 v[52:55], v71 offset:64
    ds_read_b128 v[56:59], v71 offset:128
    ds_read_b128 v[60:63], v71 offset:192
    s_lshl_b32 s54, s38, 6
    s_add_u32 s54, s54, s61
    s_add_u32 s54, s54, s46
    s_waitcnt lgkmcnt(0)
    v_mfma_f32_16x16x32_bf16 v[64:67], v[32:35], v[48:51], 0
    v_mfma_f32_16x16x32_bf16 v[64:67], v[36:39], v[52:55], v[64:67]
    v_mfma_f32_16x16x32_bf16 v[64:67], v[40:43], v[56:59], v[64:67]
    v_mfma_f32_16x16x32_bf16 v[64:67], v[44:47], v[60:63], v[64:67]
    s_mov_b64 exec, s[70:71]
    s_cmp_eq_u32 s47, 0
    s_cbranch_scc1 Lsg_11
s_nop 4
    buffer_store_dwordx4 v[64:67], v70, s[12:15], s54 offen offset:0
    s_branch Lsj_12
Lsg_11:
s_nop 4
    buffer_store_dwordx4 v[64:67], v70, s[12:15], s54 offen offset:0 sc1
Lsj_12:
    s_mov_b64 exec, -1
    s_cmp_lg_u32 s38, 0
    s_cbranch_scc1 L_QE_wait
    v_lshrrev_b32 v70, 5, v0
    v_lshlrev_b32 v70, 3, v70
    s_add_u32 s54, s61, s46
    s_mov_b32 exec_lo, 1
    s_mov_b32 exec_hi, 1
    s_cmp_eq_u32 s47, 0
    s_cbranch_scc1 Lsg_13
    buffer_store_dwordx2 v[68:69], v70, s[12:15], s54 offen offset:768
    s_branch Lsj_14
Lsg_13:
    buffer_store_dwordx2 v[68:69], v70, s[12:15], s54 offen offset:768 sc1
Lsj_14:
    s_mov_b64 exec, -1
    v_bfe_u32 v70, v0, 4, 1
    v_lshrrev_b32 v71, 5, v0
    v_lshl_add_u32 v70, v71, 1, v70
    v_lshlrev_b32 v70, 14, v70
    v_and_b32 v71, 15, v0
    v_lshl_add_u32 v70, v71, 4, v70
    s_lshl_b32 s54, s39, 17
    s_add_u32 s54, s54, s46
    s_lshl_b32 s55, s41, 8
    s_add_u32 s55, s55, s54
    s_add_u32 s56, s55, 65536
    v_and_b32 v71, 3, v0
    v_lshlrev_b32 v71, 15, v71
    s_lshl_b32 s57, s41, 3
    s_add_u32 s57, s57, s54
    s_add_u32 s64, s54, 512
    s_add_u32 s65, s64, 65536
    s_mov_b32 s48, 200000
Lpoll_15:
    buffer_load_dwordx4 v[48:51], v70, s[12:15], s55 offen offset:0 sc1
    buffer_load_dwordx4 v[52:55], v70, s[12:15], s56 offen offset:0 sc1
    buffer_load_dwordx2 v[56:57], v71, s[12:15], s57 offen offset:768 sc1
    buffer_load_dwordx4 v[60:63], v70, s[12:15], s64 offen offset:0 sc1
    buffer_load_dwordx4 v[32:35], v70, s[12:15], s65 offen offset:0 sc1
    s_waitcnt vmcnt(0)
    v_max3_u32 v36, v48, v49, v50
    v_max3_u32 v36, v36, v51, v52
    v_max3_u32 v36, v36, v53, v54
    v_max3_u32 v36, v36, v55, v56
    v_max3_u32 v36, v36, v57, v60
    v_max3_u32 v36, v36, v61, v62
    v_max3_u32 v36, v36, v63, v32
    v_max3_u32 v36, v36, v33, v34
    v_max_u32 v36, v36, v35
    v_cmp_eq_u32 vcc, -1, v36
    s_cbranch_vccz Lok_16
    s_sub_u32 s48, s48, 1
    s_cmp_lg_u32 s48, 0
    s_cbranch_scc1 Lpoll_15
Lok_16:
    v_add_f32 v60, v60, v32
    v_add_f32 v48, v48, v52
    v_add_f32 v61, v61, v33
    v_add_f32 v49, v49, v53
    v_add_f32 v62, v62, v34
    v_add_f32 v50, v50, v54
    v_add_f32 v63, v63, v35
    v_add_f32 v51, v51, v55
    v_mov_b32 v32, v60
    v_mov_b32 v33, v61
    v_mov_b32 v34, v62
    v_mov_b32 v35, v63
    v_mov_b32 v52, v48
    v_mov_b32 v53, v49
    v_mov_b32 v54, v50
    v_mov_b32 v55, v51
    v_permlane32_swap_b32 v32, v60
    v_permlane32_swap_b32 v33, v61
    v_permlane32_swap_b32 v34, v62
    v_permlane32_swap_b32 v35, v63
    v_permlane32_swap_b32 v52, v48
    v_permlane32_swap_b32 v53, v49
    v_permlane32_swap_b32 v54, v50
    v_permlane32_swap_b32 v55, v51
    v_add_f32 v60, v32, v60
    v_add_f32 v61, v33, v61
    v_add_f32 v62, v34, v62
    v_add_f32 v63, v35, v63
    v_add_f32 v48, v52, v48
    v_add_f32 v49, v53, v49
    v_add_f32 v50, v54, v50
    v_add_f32 v51, v55, v51
    v_add_f32_dpp v56, v56, v56 quad_perm:[1,0,3,2] row_mask:0xf bank_mask:0xf
    v_add_f32_dpp v57, v57, v57 quad_perm:[1,0,3,2] row_mask:0xf bank_mask:0xf
s_nop 0
    v_add_f32_dpp v56, v56, v56 quad_perm:[2,3,0,1] row_mask:0xf bank_mask:0xf
    v_add_f32_dpp v57, v57, v57 quad_perm:[2,3,0,1] row_mask:0xf bank_mask:0xf
    v_mul_f32 v56, 0x3b000000, v56
    v_mul_f32 v57, 0x3b000000, v57
    v_fma_f32 v57, -v56, v56, v57
    v_max_f32 v57, 0, v57
    v_add_f32 v57, 0x3727c5ac, v57
    v_rsq_f32 v57, v57
    v_fma_f32 v48, -v56, v60, v48
    v_fma_f32 v49, -v56, v61, v49
    v_fma_f32 v50, -v56, v62, v50
    v_fma_f32 v51, -v56, v63, v51
    v_mul_f32 v48, v57, v48
    v_mul_f32 v49, v57, v49
    v_mul_f32 v50, v57, v50
    v_mul_f32 v51, v57, v51
    v_cvt_pk_bf16_f32 v52, v48, v49
    v_cvt_pk_bf16_f32 v53, v50, v51
    v_and_b32 v70, 31, v0
    v_lshlrev_b32 v70, 3, v70
    v_add_u32 v70, 156992, v70
    ds_write_b64 v70, v[52:53]
L_QE_wait:
    v_and_b32 v71, 48, v0
    v_add_u32 v71, 156992, v71
    s_waitcnt lgkmcnt(0)
    s_barrier
    ds_read_b128 v[16:19], v71 offset:0
    ds_read_b128 v[20:23], v71 offset:64
    ds_read_b128 v[24:27], v71 offset:128
    ds_read_b128 v[28:31], v71 offset:192
    s_waitcnt lgkmcnt(0)
    s_add_u32 s99, s99, 1
    s_cmp_eq_u32 s99, 2
    s_cbranch_scc1 L_S3
L_S2:
    ds_read_b128 v[32:35], v6 offset:0
    ds_read_b128 v[36:39], v7 offset:0
    ds_read_b128 v[40:43], v8 offset:0
    ds_read_b128 v[44:47], v9 offset:0
    s_waitcnt lgkmcnt(0)
    v_mfma_f32_16x16x32_bf16 v[48:51], v[32:35], v[16:19], 0
    v_mfma_f32_16x16x32_bf16 v[48:51], v[36:39], v[20:23], v[48:51]
    v_mfma_f32_16x16x32_bf16 v[48:51], v[40:43], v[24:27], v[48:51]
    v_mfma_f32_16x16x32_bf16 v[48:51], v[44:47], v[28:31], v[48:51]
    s_add_u32 m0, s43, 0
    s_xor_b32 s66, s79, 67108864
    buffer_load_dwordx4 v2, s[4:7], s66 offen offset:0 nt lds
    buffer_load_dwordx4 v3, s[4:7], s66 offen offset:1024 nt lds
    buffer_load_dwordx4 v4, s[4:7], s66 offen offset:2048 nt lds
    buffer_load_dwordx4 v5, s[4:7], s66 offen offset:3072 nt lds
    ds_read_b128 v[32:35], v6 offset:4096
    ds_read_b128 v[36:39], v7 offset:4096
    ds_read_b128 v[40:43], v8 offset:4096
    ds_read_b128 v[44:47], v9 offset:4096
    s_waitcnt lgkmcnt(0)
    v_mfma_f32_16x16x32_bf16 v[52:55], v[32:35], v[16:19], 0
    v_mfma_f32_16x16x32_bf16 v[52:55], v[36:39], v[20:23], v[52:55]
    v_mfma_f32_16x16x32_bf16 v[52:55], v[40:43], v[24:27], v[52:55]
    v_mfma_f32_16x16x32_bf16 v[52:55], v[44:47], v[28:31], v[52:55]
    s_add_u32 m0, s43, 4096
    s_xor_b32 s66, s79, 67411968
    buffer_load_dwordx4 v2, s[4:7], s66 offen offset:0 nt lds
    buffer_load_dwordx4 v3, s[4:7], s66 offen offset:1024 nt lds
    buffer_load_dwordx4 v4, s[4:7], s66 offen offset:2048 nt lds
    buffer_load_dwordx4 v5, s[4:7], s66 offen offset:3072 nt lds
    ds_read_b128 v[32:35], v6 offset:8192
    ds_read_b128 v[36:39], v7 offset:8192
    ds_read_b128 v[40:43], v8 offset:8192
    ds_read_b128 v[44:47], v9 offset:8192
    s_lshl_b64 s[52:53], s[58:59], 8
    v_cndmask_b32 v56, v56, v48, s[52:53]
    v_cndmask_b32 v57, v57, v49, s[52:53]
    v_cndmask_b32 v58, v58, v50, s[52:53]
    v_cndmask_b32 v59, v59, v51, s[52:53]
    s_waitcnt lgkmcnt(0)
    v_mfma_f32_16x16x32_bf16 v[48:51], v[32:35], v[16:19], 0
    v_mfma_f32_16x16x32_bf16 v[48:51], v[36:39], v[20:23], v[48:51]
    v_mfma_f32_16x16x32_bf16 v[48:51], v[40:43], v[24:27], v[48:51]
    v_mfma_f32_16x16x32_bf16 v[48:51], v[44:47], v[28:31], v[48:51]
    s_add_u32 m0, s43, 8192
    s_xor_b32 s66, s79, 68042752
    buffer_load_dwordx4 v2, s[4:7], s66 offen offset:0 nt lds
    buffer_load_dwordx4 v3, s[4:7], s66 offen offset:1024 nt lds
    buffer_load_dwordx4 v4, s[4:7], s66 offen offset:2048 nt lds
    buffer_load_dwordx4 v5, s[4:7], s66 offen offset:3072 nt lds
    ds_read_b128 v[32:35], v6 offset:12288
    ds_read_b128 v[36:39], v7 offset:12288
    ds_read_b128 v[40:43], v8 offset:12288
    ds_read_b128 v[44:47], v9 offset:12288
    s_lshl_b64 s[52:53], s[58:59], 9
    v_cndmask_b32 v56, v56, v52, s[52:53]
    v_cndmask_b32 v57, v57, v53, s[52:53]
    v_cndmask_b32 v58, v58, v54, s[52:53]
    v_cndmask_b32 v59, v59, v55, s[52:53]
    s_waitcnt lgkmcnt(0)
    v_mfma_f32_16x16x32_bf16 v[52:55], v[32:35], v[16:19], 0
    v_mfma_f32_16x16x32_bf16 v[52:55], v[36:39], v[20:23], v[52:55]
    v_mfma_f32_16x16x32_bf16 v[52:55], v[40:43], v[24:27], v[52:55]
    v_mfma_f32_16x16x32_bf16 v[52:55], v[44:47], v[28:31], v[52:55]
    s_add_u32 m0, s43, 12288
    s_xor_b32 s66, s79, 67821568
    buffer_load_dwordx4 v2, s[4:7], s66 offen offset:0 nt lds
    buffer_load_dwordx4 v3, s[4:7], s66 offen offset:1024 nt lds
    buffer_load_dwordx4 v4, s[4:7], s66 offen offset:2048 nt lds
    buffer_load_dwordx4 v5, s[4:7], s66 offen offset:3072 nt lds
    ds_read_b128 v[32:35], v6 offset:16384
    ds_read_b128 v[36:39], v7 offset:16384
    ds_read_b128 v[40:43], v8 offset:16384
    ds_read_b128 v[44:47], v9 offset:16384
    s_lshl_b64 s[52:53], s[58:59], 10
    v_cndmask_b32 v56, v56, v48, s[52:53]
    v_cndmask_b32 v57, v57, v49, s[52:53]
    v_cndmask_b32 v58, v58, v50, s[52:53]
    v_cndmask_b32 v59, v59, v51, s[52:53]
    s_waitcnt lgkmcnt(0)
    v_mfma_f32_16x16x32_bf16 v[48:51], v[32:35], v[16:19], 0
    v_mfma_f32_16x16x32_bf16 v[48:51], v[36:39], v[20:23], v[48:51]
    v_mfma_f32_16x16x32_bf16 v[48:51], v[40:43], v[24:27], v[48:51]
    v_mfma_f32_16x16x32_bf16 v[48:51], v[44:47], v[28:31], v[48:51]
    s_add_u32 m0, s43, 16384
    s_xor_b32 s66, s79, 67338240
    buffer_load_dwordx4 v2, s[4:7], s66 offen offset:0 nt lds
    buffer_load_dwordx4 v3, s[4:7], s66 offen offset:1024 nt lds
    buffer_load_dwordx4 v4, s[4:7], s66 offen offset:2048 nt lds
    buffer_load_dwordx4 v5, s[4:7], s66 offen offset:3072 nt lds
    ds_read_b128 v[32:35], v6 offset:20480
    ds_read_b128 v[36:39], v7 offset:20480
    ds_read_b128 v[40:43], v8 offset:20480
    ds_read_b128 v[44:47], v9 offset:20480
    s_lshl_b64 s[52:53], s[58:59], 11
    v_cndmask_b32 v56, v56, v52, s[52:53]
    v_cndmask_b32 v57, v57, v53, s[52:53]
    v_cndmask_b32 v58, v58, v54, s[52:53]
    v_cndmask_b32 v59, v59, v55, s[52:53]
    s_waitcnt lgkmcnt(0)
    v_mfma_f32_16x16x32_bf16 v[52:55], v[32:35], v[16:19], 0
    v_mfma_f32_16x16x32_bf16 v[52:55], v[36:39], v[20:23], v[52:55]
    v_mfma_f32_16x16x32_bf16 v[52:55], v[40:43], v[24:27], v[52:55]
    v_mfma_f32_16x16x32_bf16 v[52:55], v[44:47], v[28:31], v[52:55]
    s_add_u32 m0, s43, 20480
    s_xor_b32 s66, s79, 67575808
    buffer_load_dwordx4 v2, s[4:7], s66 offen offset:0 nt lds
    buffer_load_dwordx4 v3, s[4:7], s66 offen offset:1024 nt lds
    buffer_load_dwordx4 v4, s[4:7], s66 offen offset:2048 nt lds
    buffer_load_dwordx4 v5, s[4:7], s66 offen offset:3072 nt lds
    ds_read_b128 v[32:35], v6 offset:24576
    ds_read_b128 v[36:39], v7 offset:24576
    ds_read_b128 v[40:43], v8 offset:24576
    ds_read_b128 v[44:47], v9 offset:24576
    s_lshl_b64 s[52:53], s[58:59], 12
    v_cndmask_b32 v56, v56, v48, s[52:53]
    v_cndmask_b32 v57, v57, v49, s[52:53]
    v_cndmask_b32 v58, v58, v50, s[52:53]
    v_cndmask_b32 v59, v59, v51, s[52:53]
    s_waitcnt lgkmcnt(0)
    v_mfma_f32_16x16x32_bf16 v[48:51], v[32:35], v[16:19], 0
    v_mfma_f32_16x16x32_bf16 v[48:51], v[36:39], v[20:23], v[48:51]
    v_mfma_f32_16x16x32_bf16 v[48:51], v[40:43], v[24:27], v[48:51]
    v_mfma_f32_16x16x32_bf16 v[48:51], v[44:47], v[28:31], v[48:51]
    s_add_u32 m0, s43, 24576
    s_xor_b32 s66, s79, 68009984
    buffer_load_dwordx4 v2, s[4:7], s66 offen offset:0 nt lds
    buffer_load_dwordx4 v3, s[4:7], s66 offen offset:1024 nt lds
    buffer_load_dwordx4 v4, s[4:7], s66 offen offset:2048 nt lds
    buffer_load_dwordx4 v5, s[4:7], s66 offen offset:3072 nt lds
    ds_read_b128 v[32:35], v6 offset:28672
    ds_read_b128 v[36:39], v7 offset:28672
    ds_read_b128 v[40:43], v8 offset:28672
    ds_read_b128 v[44:47], v9 offset:28672
    s_lshl_b64 s[52:53], s[58:59], 13
    v_cndmask_b32 v56, v56, v52, s[52:53]
    v_cndmask_b32 v57, v57, v53, s[52:53]
    v_cndmask_b32 v58, v58, v54, s[52:53]
    v_cndmask_b32 v59, v59, v55, s[52:53]
    s_waitcnt lgkmcnt(0)
    v_mfma_f32_16x16x32_bf16 v[52:55], v[32:35], v[16:19], 0
    v_mfma_f32_16x16x32_bf16 v[52:55], v[36:39], v[20:23], v[52:55]
    v_mfma_f32_16x16x32_bf16 v[52:55], v[40:43], v[24:27], v[52:55]
    v_mfma_f32_16x16x32_bf16 v[52:55], v[44:47], v[28:31], v[52:55]
    s_add_u32 m0, s43, 28672
    s_xor_b32 s66, s79, 67723264
    buffer_load_dwordx4 v2, s[4:7], s66 offen offset:0 nt lds
    buffer_load_dwordx4 v3, s[4:7], s66 offen offset:1024 nt lds
    buffer_load_dwordx4 v4, s[4:7], s66 offen offset:2048 nt lds
    buffer_load_dwordx4 v5, s[4:7], s66 offen offset:3072 nt lds
    s_lshl_b64 s[52:53], s[58:59], 14
    v_cndmask_b32 v56, v56, v48, s[52:53]
    v_cndmask_b32 v57, v57, v49, s[52:53]
    v_cndmask_b32 v58, v58, v50, s[52:53]
    v_cndmask_b32 v59, v59, v51, s[52:53]
    s_waitcnt lgkmcnt(0)
    v_mfma_f32_16x16x32_bf16 v[48:51], v[72:75], v[16:19], 0
    v_mfma_f32_16x16x32_bf16 v[48:51], v[76:79], v[20:23], v[48:51]
    v_mfma_f32_16x16x32_bf16 v[48:51], v[80:83], v[24:27], v[48:51]
    v_mfma_f32_16x16x32_bf16 v[48:51], v[84:87], v[28:31], v[48:51]
    s_lshl_b64 s[52:53], s[58:59], 15
    v_cndmask_b32 v56, v56, v52, s[52:53]
    v_cndmask_b32 v57, v57, v53, s[52:53]
    v_cndmask_b32 v58, v58, v54, s[52:53]
    v_cndmask_b32 v59, v59, v55, s[52:53]
    s_waitcnt lgkmcnt(0)
    v_mfma_f32_16x16x32_bf16 v[52:55], v[88:91], v[16:19], 0
    v_mfma_f32_16x16x32_bf16 v[52:55], v[92:95], v[20:23], v[52:55]
    v_mfma_f32_16x16x32_bf16 v[52:55], v[96:99], v[24:27], v[52:55]
    v_mfma_f32_16x16x32_bf16 v[52:55], v[100:103], v[28:31], v[52:55]
    s_lshl_b64 s[52:53], s[58:59], 0
    v_cndmask_b32 v56, v56, v48, s[52:53]
    v_cndmask_b32 v57, v57, v49, s[52:53]
    v_cndmask_b32 v58, v58, v50, s[52:53]
    v_cndmask_b32 v59, v59, v51, s[52:53]
    s_waitcnt lgkmcnt(0)
    v_mfma_f32_16x16x32_bf16 v[48:51], v[104:107], v[16:19], 0
    v_mfma_f32_16x16x32_bf16 v[48:51], v[108:111], v[20:23], v[48:51]
    v_mfma_f32_16x16x32_bf16 v[48:51], v[112:115], v[24:27], v[48:51]
    v_mfma_f32_16x16x32_bf16 v[48:51], v[116:119], v[28:31], v[48:51]
    s_lshl_b64 s[52:53], s[58:59], 1
    v_cndmask_b32 v56, v56, v52, s[52:53]
    v_cndmask_b32 v57, v57, v53, s[52:53]
    v_cndmask_b32 v58, v58, v54, s[52:53]
    v_cndmask_b32 v59, v59, v55, s[52:53]
    s_waitcnt lgkmcnt(0)
    v_mfma_f32_16x16x32_bf16 v[52:55], v[120:123], v[16:19], 0
    v_mfma_f32_16x16x32_bf16 v[52:55], v[124:127], v[20:23], v[52:55]
    v_mfma_f32_16x16x32_bf16 v[52:55], v[128:131], v[24:27], v[52:55]
    v_mfma_f32_16x16x32_bf16 v[52:55], v[132:135], v[28:31], v[52:55]
    s_lshl_b64 s[52:53], s[58:59], 2
    v_cndmask_b32 v56, v56, v48, s[52:53]
    v_cndmask_b32 v57, v57, v49, s[52:53]
    v_cndmask_b32 v58, v58, v50, s[52:53]
    v_cndmask_b32 v59, v59, v51, s[52:53]
    s_waitcnt lgkmcnt(0)
    v_mfma_f32_16x16x32_bf16 v[48:51], v[136:139], v[16:19], 0
    v_mfma_f32_16x16x32_bf16 v[48:51], v[140:143], v[20:23], v[48:51]
    v_mfma_f32_16x16x32_bf16 v[48:51], v[144:147], v[24:27], v[48:51]
    v_mfma_f32_16x16x32_bf16 v[48:51], v[148:151], v[28:31], v[48:51]
    s_lshl_b64 s[52:53], s[58:59], 3
    v_cndmask_b32 v56, v56, v52, s[52:53]
    v_cndmask_b32 v57, v57, v53, s[52:53]
    v_cndmask_b32 v58, v58, v54, s[52:53]
    v_cndmask_b32 v59, v59, v55, s[52:53]
    s_waitcnt lgkmcnt(0)
    v_mfma_f32_16x16x32_bf16 v[52:55], v[152:155], v[16:19], 0
    v_mfma_f32_16x16x32_bf16 v[52:55], v[156:159], v[20:23], v[52:55]
    v_mfma_f32_16x16x32_bf16 v[52:55], v[160:163], v[24:27], v[52:55]
    v_mfma_f32_16x16x32_bf16 v[52:55], v[164:167], v[28:31], v[52:55]
    s_lshl_b64 s[52:53], s[58:59], 4
    v_cndmask_b32 v56, v56, v48, s[52:53]
    v_cndmask_b32 v57, v57, v49, s[52:53]
    v_cndmask_b32 v58, v58, v50, s[52:53]
    v_cndmask_b32 v59, v59, v51, s[52:53]
    s_waitcnt lgkmcnt(0)
    v_mfma_f32_16x16x32_bf16 v[48:51], v[168:171], v[16:19], 0
    v_mfma_f32_16x16x32_bf16 v[48:51], v[172:175], v[20:23], v[48:51]
    v_mfma_f32_16x16x32_bf16 v[48:51], v[176:179], v[24:27], v[48:51]
    v_mfma_f32_16x16x32_bf16 v[48:51], v[180:183], v[28:31], v[48:51]
    s_lshl_b64 s[52:53], s[58:59], 5
    v_cndmask_b32 v56, v56, v52, s[52:53]
    v_cndmask_b32 v57, v57, v53, s[52:53]
    v_cndmask_b32 v58, v58, v54, s[52:53]
    v_cndmask_b32 v59, v59, v55, s[52:53]
    s_waitcnt lgkmcnt(0)
    v_mfma_f32_16x16x32_bf16 v[52:55], v[184:187], v[16:19], 0
    v_mfma_f32_16x16x32_bf16 v[52:55], v[188:191], v[20:23], v[52:55]
    v_mfma_f32_16x16x32_bf16 v[52:55], v[192:195], v[24:27], v[52:55]
    v_mfma_f32_16x16x32_bf16 v[52:55], v[196:199], v[28:31], v[52:55]
    s_lshl_b64 s[52:53], s[58:59], 6
    v_cndmask_b32 v56, v56, v48, s[52:53]
    v_cndmask_b32 v57, v57, v49, s[52:53]
    v_cndmask_b32 v58, v58, v50, s[52:53]
    v_cndmask_b32 v59, v59, v51, s[52:53]
    s_lshl_b64 s[52:53], s[58:59], 7
s_nop 1
    v_cndmask_b32 v56, v56, v52, s[52:53]
    v_cndmask_b32 v57, v57, v53, s[52:53]
    v_cndmask_b32 v58, v58, v54, s[52:53]
    v_cndmask_b32 v59, v59, v55, s[52:53]
    v_max3_f32 v70, v56, v57, v58
    v_max_f32 v70, v70, v59
s_nop 1
    v_max_f32_dpp v70, v70, v70 row_ror:8 row_mask:0xf bank_mask:0xf
s_nop 1
    v_max_f32_dpp v70, v70, v70 row_ror:4 row_mask:0xf bank_mask:0xf
s_nop 1
    v_max_f32_dpp v70, v70, v70 row_ror:2 row_mask:0xf bank_mask:0xf
s_nop 1
    v_max_f32_dpp v70, v70, v70 row_ror:1 row_mask:0xf bank_mask:0xf
    v_mov_b32 v71, v70
s_nop 1
    v_permlane16_swap_b32 v71, v70
    v_max_f32 v70, v71, v70
    v_mov_b32 v71, v70
s_nop 1
    v_permlane32_swap_b32 v71, v70
    v_max_f32 v70, v71, v70
    v_mov_b32 v68, v70
    v_mul_f32 v70, s60, v68
    v_fma_f32 v56, v56, s60, -v70
    v_fma_f32 v57, v57, s60, -v70
    v_fma_f32 v58, v58, s60, -v70
    v_fma_f32 v59, v59, s60, -v70
    v_exp_f32 v56, v56
    v_exp_f32 v57, v57
    v_exp_f32 v58, v58
    v_exp_f32 v59, v59
    v_cvt_pk_bf16_f32 v48, v56, v56
    v_cvt_pk_bf16_f32 v49, v57, v57
    v_cvt_pk_bf16_f32 v50, v58, v58
    v_cvt_pk_bf16_f32 v51, v59, v59
    ds_write_b32 v14, v48 offset:0
    ds_write_b32 v14, v49 offset:144
    ds_write_b32 v14, v50 offset:288
    ds_write_b32 v14, v51 offset:432
    v_add_f32 v56, v56, v57
    v_add_f32 v58, v58, v59
    v_add_f32 v56, v56, v58
    v_mov_b32 v69, v56
    s_waitcnt lgkmcnt(0)
    ds_read_b128 v[40:43], v15 offset:0
    s_waitcnt lgkmcnt(0)
    ds_read_b128 v[44:47], v15 offset:16
    v_and_b32 v32, v40, v10
    v_and_b32 v33, v40, v11
    v_and_b32 v34, v40, v12
    v_and_b32 v35, v40, v13
    v_and_b32 v36, v41, v10
    v_and_b32 v37, v41, v11
    v_mfma_f32_16x16x32_bf16 v[60:63], a[0:3], v[32:35], 0
    v_and_b32 v38, v41, v12
    v_and_b32 v39, v41, v13
    v_mfma_f32_16x16x32_bf16 v[64:67], a[4:7], v[32:35], 0
    v_and_b32 v32, v42, v10
    v_and_b32 v33, v42, v11
    v_mfma_f32_16x16x32_bf16 v[60:63], a[8:11], v[36:39], v[60:63]
    v_and_b32 v34, v42, v12
    v_and_b32 v35, v42, v13
    v_mfma_f32_16x16x32_bf16 v[64:67], a[12:15], v[36:39], v[64:67]
    s_xor_b32 s67, s79, 67108864
    buffer_load_dwordx4 a[0:3], v1, s[8:11], s67 offen offset:0 nt
    buffer_load_dwordx4 a[4:7], v1, s[8:11], s67 offen offset:1024 nt
    buffer_load_dwordx4 a[8:11], v1, s[8:11], s67 offen offset:2048 nt
    buffer_load_dwordx4 a[12:15], v1, s[8:11], s67 offen offset:3072 nt
    v_and_b32 v36, v43, v10
    v_and_b32 v37, v43, v11
    v_mfma_f32_16x16x32_bf16 v[60:63], a[16:19], v[32:35], v[60:63]
    v_and_b32 v38, v43, v12
    v_and_b32 v39, v43, v13
    v_mfma_f32_16x16x32_bf16 v[64:67], a[20:23], v[32:35], v[64:67]
    s_waitcnt lgkmcnt(0)
    v_and_b32 v32, v44, v10
    v_and_b32 v33, v44, v11
    v_mfma_f32_16x16x32_bf16 v[60:63], a[24:27], v[36:39], v[60:63]
    v_and_b32 v34, v44, v12
    v_and_b32 v35, v44, v13
    v_mfma_f32_16x16x32_bf16 v[64:67], a[28:31], v[36:39], v[64:67]
    ds_read_b128 v[40:43], v15 offset:32
    s_xor_b32 s67, s79, 67411968
    buffer_load_dwordx4 a[16:19], v1, s[8:11], s67 offen offset:0 nt
    buffer_load_dwordx4 a[20:23], v1, s[8:11], s67 offen offset:1024 nt
    buffer_load_dwordx4 a[24:27], v1, s[8:11], s67 offen offset:2048 nt
    buffer_load_dwordx4 a[28:31], v1, s[8:11], s67 offen offset:3072 nt
    v_and_b32 v36, v45, v10
    v_and_b32 v37, v45, v11
    v_mfma_f32_16x16x32_bf16 v[60:63], a[32:35], v[32:35], v[60:63]
    v_and_b32 v38, v45, v12
    v_and_b32 v39, v45, v13
    v_mfma_f32_16x16x32_bf16 v[64:67], a[36:39], v[32:35], v[64:67]
    v_and_b32 v32, v46, v10
    v_and_b32 v33, v46, v11
    v_mfma_f32_16x16x32_bf16 v[60:63], a[40:43], v[36:39], v[60:63]
    v_and_b32 v34, v46, v12
    v_and_b32 v35, v46, v13
    v_mfma_f32_16x16x32_bf16 v[64:67], a[44:47], v[36:39], v[64:67]
    s_xor_b32 s67, s79, 68042752
    buffer_load_dwordx4 a[32:35], v1, s[8:11], s67 offen offset:0 nt
    buffer_load_dwordx4 a[36:39], v1, s[8:11], s67 offen offset:1024 nt
    buffer_load_dwordx4 a[40:43], v1, s[8:11], s67 offen offset:2048 nt
    buffer_load_dwordx4 a[44:47], v1, s[8:11], s67 offen offset:3072 nt
    v_and_b32 v36, v47, v10
    v_and_b32 v37, v47, v11
    v_mfma_f32_16x16x32_bf16 v[60:63], a[48:51], v[32:35], v[60:63]
    v_and_b32 v38, v47, v12
    v_and_b32 v39, v47, v13
    v_mfma_f32_16x16x32_bf16 v[64:67], a[52:55], v[32:35], v[64:67]
    s_waitcnt lgkmcnt(0)
    v_and_b32 v32, v40, v10
    v_and_b32 v33, v40, v11
    v_mfma_f32_16x16x32_bf16 v[60:63], a[56:59], v[36:39], v[60:63]
    v_and_b32 v34, v40, v12
    v_and_b32 v35, v40, v13
    v_mfma_f32_16x16x32_bf16 v[64:67], a[60:63], v[36:39], v[64:67]
    ds_read_b128 v[44:47], v15 offset:48
    s_xor_b32 s67, s79, 67821568
    buffer_load_dwordx4 a[48:51], v1, s[8:11], s67 offen offset:0 nt
    buffer_load_dwordx4 a[52:55], v1, s[8:11], s67 offen offset:1024 nt
    buffer_load_dwordx4 a[56:59], v1, s[8:11], s67 offen offset:2048 nt
    buffer_load_dwordx4 a[60:63], v1, s[8:11], s67 offen offset:3072 nt
    v_and_b32 v36, v41, v10
    v_and_b32 v37, v41, v11
    v_mfma_f32_16x16x32_bf16 v[60:63], a[64:67], v[32:35], v[60:63]
    v_and_b32 v38, v41, v12
    v_and_b32 v39, v41, v13
    v_mfma_f32_16x16x32_bf16 v[64:67], a[68:71], v[32:35], v[64:67]
    v_and_b32 v32, v42, v10
    v_and_b32 v33, v42, v11
    v_mfma_f32_16x16x32_bf16 v[60:63], a[72:75], v[36:39], v[60:63]
    v_and_b32 v34, v42, v12
    v_and_b32 v35, v42, v13
    v_mfma_f32_16x16x32_bf16 v[64:67], a[76:79], v[36:39], v[64:67]
    v_and_b32 v36, v43, v10
    v_and_b32 v37, v43, v11
    v_mfma_f32_16x16x32_bf16 v[60:63], a[80:83], v[32:35], v[60:63]
    v_and_b32 v38, v43, v12
    v_and_b32 v39, v43, v13
    v_mfma_f32_16x16x32_bf16 v[64:67], a[84:87], v[32:35], v[64:67]
    s_waitcnt lgkmcnt(0)
    v_and_b32 v32, v44, v10
    v_and_b32 v33, v44, v11
    v_mfma_f32_16x16x32_bf16 v[60:63], a[88:91], v[36:39], v[60:63]
    v_and_b32 v34, v44, v12
    v_and_b32 v35, v44, v13
    v_mfma_f32_16x16x32_bf16 v[64:67], a[92:95], v[36:39], v[64:67]
    ds_read_b128 v[40:43], v15 offset:64
    v_and_b32 v36, v45, v10
    v_and_b32 v37, v45, v11
    v_mfma_f32_16x16x32_bf16 v[60:63], a[96:99], v[32:35], v[60:63]
    v_and_b32 v38, v45, v12
    v_and_b32 v39, v45, v13
    v_mfma_f32_16x16x32_bf16 v[64:67], a[100:103], v[32:35], v[64:67]
    v_and_b32 v32, v46, v10
    v_and_b32 v33, v46, v11
    v_mfma_f32_16x16x32_bf16 v[60:63], a[104:107], v[36:39], v[60:63]
    v_and_b32 v34, v46, v12
    v_and_b32 v35, v46, v13
    v_mfma_f32_16x16x32_bf16 v[64:67], a[108:111], v[36:39], v[64:67]
    v_and_b32 v36, v47, v10
    v_and_b32 v37, v47, v11
    v_mfma_f32_16x16x32_bf16 v[60:63], a[112:115], v[32:35], v[60:63]
    v_and_b32 v38, v47, v12
    v_and_b32 v39, v47, v13
    v_mfma_f32_16x16x32_bf16 v[64:67], a[116:119], v[32:35], v[64:67]
    s_waitcnt lgkmcnt(0)
    v_and_b32 v32, v40, v10
    v_and_b32 v33, v40, v11
    v_mfma_f32_16x16x32_bf16 v[60:63], a[120:123], v[36:39], v[60:63]
    v_and_b32 v34, v40, v12
    v_and_b32 v35, v40, v13
    v_mfma_f32_16x16x32_bf16 v[64:67], a[124:127], v[36:39], v[64:67]
    ds_read_b128 v[44:47], v15 offset:80
    v_and_b32 v36, v41, v10
    v_and_b32 v37, v41, v11
    v_mfma_f32_16x16x32_bf16 v[60:63], a[128:131], v[32:35], v[60:63]
    v_and_b32 v38, v41, v12
    v_and_b32 v39, v41, v13
    v_mfma_f32_16x16x32_bf16 v[64:67], a[132:135], v[32:35], v[64:67]
    v_and_b32 v32, v42, v10
    v_and_b32 v33, v42, v11
    v_mfma_f32_16x16x32_bf16 v[60:63], a[136:139], v[36:39], v[60:63]
    v_and_b32 v34, v42, v12
    v_and_b32 v35, v42, v13
    v_mfma_f32_16x16x32_bf16 v[64:67], a[140:143], v[36:39], v[64:67]
    v_and_b32 v36, v43, v10
    v_and_b32 v37, v43, v11
    v_mfma_f32_16x16x32_bf16 v[60:63], a[144:147], v[32:35], v[60:63]
    v_and_b32 v38, v43, v12
    v_and_b32 v39, v43, v13
    v_mfma_f32_16x16x32_bf16 v[64:67], a[148:151], v[32:35], v[64:67]
    s_waitcnt lgkmcnt(0)
    v_and_b32 v32, v44, v10
    v_and_b32 v33, v44, v11
    v_mfma_f32_16x16x32_bf16 v[60:63], a[152:155], v[36:39], v[60:63]
    v_and_b32 v34, v44, v12
    v_and_b32 v35, v44, v13
    v_mfma_f32_16x16x32_bf16 v[64:67], a[156:159], v[36:39], v[64:67]
    ds_read_b128 v[40:43], v15 offset:96
    v_and_b32 v36, v45, v10
    v_and_b32 v37, v45, v11
    v_mfma_f32_16x16x32_bf16 v[60:63], a[160:163], v[32:35], v[60:63]
    v_and_b32 v38, v45, v12
    v_and_b32 v39, v45, v13
    v_mfma_f32_16x16x32_bf16 v[64:67], a[164:167], v[32:35], v[64:67]
    v_and_b32 v32, v46, v10
    v_and_b32 v33, v46, v11
    v_mfma_f32_16x16x32_bf16 v[60:63], a[168:171], v[36:39], v[60:63]
    v_and_b32 v34, v46, v12
    v_and_b32 v35, v46, v13
    v_mfma_f32_16x16x32_bf16 v[64:67], a[172:175], v[36:39], v[64:67]
    v_and_b32 v36, v47, v10
    v_and_b32 v37, v47, v11
    v_mfma_f32_16x16x32_bf16 v[60:63], a[176:179], v[32:35], v[60:63]
    v_and_b32 v38, v47, v12
    v_and_b32 v39, v47, v13
    v_mfma_f32_16x16x32_bf16 v[64:67], a[180:183], v[32:35], v[64:67]
    s_waitcnt lgkmcnt(0)
    v_and_b32 v32, v40, v10
    v_and_b32 v33, v40, v11
    v_mfma_f32_16x16x32_bf16 v[60:63], a[184:187], v[36:39], v[60:63]
    v_and_b32 v34, v40, v12
    v_and_b32 v35, v40, v13
    v_mfma_f32_16x16x32_bf16 v[64:67], a[188:191], v[36:39], v[64:67]
    ds_read_b128 v[44:47], v15 offset:112
    v_and_b32 v36, v41, v10
    v_and_b32 v37, v41, v11
    v_mfma_f32_16x16x32_bf16 v[60:63], a[192:195], v[32:35], v[60:63]
    v_and_b32 v38, v41, v12
    v_and_b32 v39, v41, v13
    v_mfma_f32_16x16x32_bf16 v[64:67], a[196:199], v[32:35], v[64:67]
    v_and_b32 v32, v42, v10
    v_and_b32 v33, v42, v11
    v_mfma_f32_16x16x32_bf16 v[60:63], a[200:203], v[36:39], v[60:63]
    v_and_b32 v34, v42, v12
    v_and_b32 v35, v42, v13
    v_mfma_f32_16x16x32_bf16 v[64:67], a[204:207], v[36:39], v[64:67]
    v_and_b32 v36, v43, v10
    v_and_b32 v37, v43, v11
    v_mfma_f32_16x16x32_bf16 v[60:63], a[208:211], v[32:35], v[60:63]
    v_and_b32 v38, v43, v12
    v_and_b32 v39, v43, v13
    v_mfma_f32_16x16x32_bf16 v[64:67], a[212:215], v[32:35], v[64:67]
    s_waitcnt lgkmcnt(0)
    v_and_b32 v32, v44, v10
    v_and_b32 v33, v44, v11
    v_mfma_f32_16x16x32_bf16 v[60:63], a[216:219], v[36:39], v[60:63]
    v_and_b32 v34, v44, v12
    v_and_b32 v35, v44, v13
    v_mfma_f32_16x16x32_bf16 v[64:67], a[220:223], v[36:39], v[64:67]
    v_and_b32 v36, v45, v10
    v_and_b32 v37, v45, v11
    v_mfma_f32_16x16x32_bf16 v[60:63], a[224:227], v[32:35], v[60:63]
    v_and_b32 v38, v45, v12
    v_and_b32 v39, v45, v13
    v_mfma_f32_16x16x32_bf16 v[64:67], a[228:231], v[32:35], v[64:67]
    v_and_b32 v32, v46, v10
    v_and_b32 v33, v46, v11
    v_mfma_f32_16x16x32_bf16 v[60:63], a[232:235], v[36:39], v[60:63]
    v_and_b32 v34, v46, v12
    v_and_b32 v35, v46, v13
    v_mfma_f32_16x16x32_bf16 v[64:67], a[236:239], v[36:39], v[64:67]
    v_and_b32 v36, v47, v10
    v_and_b32 v37, v47, v11
    v_mfma_f32_16x16x32_bf16 v[60:63], a[240:243], v[32:35], v[60:63]
    v_and_b32 v38, v47, v12
    v_and_b32 v39, v47, v13
    v_mfma_f32_16x16x32_bf16 v[64:67], a[244:247], v[32:35], v[64:67]
s_nop 0
    v_mfma_f32_16x16x32_bf16 v[60:63], a[248:251], v[36:39], v[60:63]
    v_mfma_f32_16x16x32_bf16 v[64:67], a[252:255], v[36:39], v[64:67]
    v_add_f32_dpp v69, v69, v69 row_ror:8 row_mask:0xf bank_mask:0xf
s_nop 1
    v_add_f32_dpp v69, v69, v69 row_ror:4 row_mask:0xf bank_mask:0xf
s_nop 1
    v_add_f32_dpp v69, v69, v69 row_ror:2 row_mask:0xf bank_mask:0xf
s_nop 1
    v_add_f32_dpp v69, v69, v69 row_ror:1 row_mask:0xf bank_mask:0xf
    v_mov_b32 v70, v69
s_nop 1
    v_permlane16_swap_b32 v70, v69
    v_add_f32 v69, v70, v69
    v_mov_b32 v70, v69
s_nop 1
    v_permlane32_swap_b32 v70, v69
    v_add_f32 v69, v70, v69
    s_lshl_b32 s54, s38, 3
    s_add_u32 s54, s54, 156160
    v_mov_b32 v70, s54
    ds_write_b64 v70, v[68:69]
    v_and_b32 v70, 15, v0
    v_lshrrev_b32 v71, 3, v70
    s_lshl_b32 s54, s38, 1
    v_add_u32 v71, s54, v71
    v_lshlrev_b32 v71, 9, v71
    v_and_b32 v70, 7, v70
    v_lshl_add_u32 v71, v70, 2, v71
    v_lshrrev_b32 v70, 4, v0
    v_lshl_add_u32 v71, v70, 7, v71
    v_add_u32 v71, 152064, v71
    v_cndmask_b32 v48, v64, v60, s[62:63]
    v_cndmask_b32 v49, v65, v61, s[62:63]
    v_cndmask_b32 v50, v66, v62, s[62:63]
    v_cndmask_b32 v51, v67, v63, s[62:63]
    ds_write_b32 v71, v48 offset:0
    ds_write_b32 v71, v49 offset:32
    ds_write_b32 v71, v50 offset:64
    ds_write_b32 v71, v51 offset:96
    s_and_b32 s54, s38, 1
    s_lshl_b32 s54, s54, 8
    v_lshlrev_b32 v32, 2, v0
    v_add_u32 v32, s54, v32
    v_add_u32 v70, 152064, v32
    v_mov_b32 v71, 156160
    s_waitcnt lgkmcnt(0)
    s_barrier
    ds_read_b32 v48, v70 offset:0
    ds_read_b32 v49, v70 offset:512
    ds_read_b32 v50, v70 offset:1024
    ds_read_b32 v51, v70 offset:1536
    ds_read_b32 v52, v70 offset:2048
    ds_read_b32 v53, v70 offset:2560
    ds_read_b32 v54, v70 offset:3072
    ds_read_b32 v55, v70 offset:3584
    ds_read_b128 v[56:59], v71
    ds_read_b128 v[60:63], v71 offset:16
    s_add_u32 s54, s61, s46
    s_mov_b32 s55, s54
    s_waitcnt lgkmcnt(0)
    v_max3_f32 v64, v56, v58, v60
    v_max_f32 v64, v64, v62
    v_sub_f32 v56, v56, v64
    v_sub_f32 v58, v58, v64
    v_sub_f32 v60, v60, v64
    v_sub_f32 v62, v62, v64
    v_mul_f32 v56, s60, v56
    v_mul_f32 v58, s60, v58
    v_mul_f32 v60, s60, v60
    v_mul_f32 v62, s60, v62
    v_exp_f32 v56, v56
    v_exp_f32 v58, v58
    v_exp_f32 v60, v60
    v_exp_f32 v62, v62
    v_add_f32 v48, v48, v49
    v_add_f32 v50, v50, v51
    v_add_f32 v52, v52, v53
    v_add_f32 v54, v54, v55
    v_mul_f32 v48, v56, v48
    v_mul_f32 v65, v56, v57
    v_fmac_f32 v48, v58, v50
    v_fmac_f32 v65, v58, v59
    v_fmac_f32 v48, v60, v52
    v_fmac_f32 v65, v60, v61
    v_fmac_f32 v48, v62, v54
    v_fmac_f32 v65, v62, v63
    s_cmp_ge_u32 s38, 2
    s_cbranch_scc1 Lop_17
    s_cmp_eq_u32 s47, 0
    s_cbranch_scc1 Lsg_18
    buffer_store_dword v48, v32, s[12:15], s54 offen offset:1024
    s_branch Lsj_19
Lsg_18:
    buffer_store_dword v48, v32, s[12:15], s54 offen offset:1024 sc1
Lsj_19:
    s_cmp_lg_u32 s38, 0
    s_cbranch_scc1 Lop_17
    s_mov_b64 s[50:51], exec
    s_mov_b64 exec, 1
    s_cmp_eq_u32 s47, 0
    s_cbranch_scc1 Lsg_20
    buffer_store_dwordx2 v[64:65], off, s[12:15], s55 offset:784
    s_branch Lsj_21
Lsg_20:
    buffer_store_dwordx2 v[64:65], off, s[12:15], s55 offset:784 sc1
Lsj_21:
    s_mov_b64 exec, s[50:51]
Lop_17:
    s_barrier
    v_and_b32 v71, 48, v0
    v_add_u32 v71, 160800, v71
    ds_read_b128 v[16:19], v71 offset:0
    ds_read_b128 v[20:23], v71 offset:64
    ds_read_b128 v[24:27], v71 offset:128
    ds_read_b128 v[28:31], v71 offset:192
    s_waitcnt lgkmcnt(0)
    s_waitcnt vmcnt(44)
    ds_read_b128 v[72:75], v6 offset:0
    ds_read_b128 v[76:79], v7 offset:0
    ds_read_b128 v[80:83], v8 offset:0
    ds_read_b128 v[84:87], v9 offset:0
    s_waitcnt lgkmcnt(0)
    v_mfma_f32_16x16x32_bf16 v[48:51], v[72:75], v[16:19], 0
    v_mfma_f32_16x16x32_bf16 v[48:51], v[76:79], v[20:23], v[48:51]
    v_mfma_f32_16x16x32_bf16 v[48:51], v[80:83], v[24:27], v[48:51]
    v_mfma_f32_16x16x32_bf16 v[48:51], v[84:87], v[28:31], v[48:51]
    s_add_u32 m0, s43, 0
    s_xor_b32 s66, s79, 69103616
    buffer_load_dwordx4 v2, s[4:7], s66 offen offset:0 nt lds
    buffer_load_dwordx4 v3, s[4:7], s66 offen offset:1024 nt lds
    buffer_load_dwordx4 v4, s[4:7], s66 offen offset:2048 nt lds
    buffer_load_dwordx4 v5, s[4:7], s66 offen offset:3072 nt lds
    s_waitcnt vmcnt(44)
    ds_read_b128 v[88:91], v6 offset:4096
    ds_read_b128 v[92:95], v7 offset:4096
    ds_read_b128 v[96:99], v8 offset:4096
    ds_read_b128 v[100:103], v9 offset:4096
    s_waitcnt lgkmcnt(0)
    v_mfma_f32_16x16x32_bf16 v[52:55], v[88:91], v[16:19], 0
    v_mfma_f32_16x16x32_bf16 v[52:55], v[92:95], v[20:23], v[52:55]
    v_mfma_f32_16x16x32_bf16 v[52:55], v[96:99], v[24:27], v[52:55]
    v_mfma_f32_16x16x32_bf16 v[52:55], v[100:103], v[28:31], v[52:55]
    s_add_u32 m0, s43, 4096
    s_xor_b32 s66, s79, 68866048
    buffer_load_dwordx4 v2, s[4:7], s66 offen offset:0 nt lds
    buffer_load_dwordx4 v3, s[4:7], s66 offen offset:1024 nt lds
    buffer_load_dwordx4 v4, s[4:7], s66 offen offset:2048 nt lds
    buffer_load_dwordx4 v5, s[4:7], s66 offen offset:3072 nt lds
    s_waitcnt vmcnt(44)
    ds_read_b128 v[104:107], v6 offset:8192
    ds_read_b128 v[108:111], v7 offset:8192
    ds_read_b128 v[112:115], v8 offset:8192
    ds_read_b128 v[116:119], v9 offset:8192
    s_lshl_b64 s[52:53], s[58:59], 0
    v_cndmask_b32 v56, v56, v48, s[52:53]
    v_cndmask_b32 v57, v57, v49, s[52:53]
    v_cndmask_b32 v58, v58, v50, s[52:53]
    v_cndmask_b32 v59, v59, v51, s[52:53]
    s_waitcnt lgkmcnt(0)
    v_mfma_f32_16x16x32_bf16 v[48:51], v[104:107], v[16:19], 0
    v_mfma_f32_16x16x32_bf16 v[48:51], v[108:111], v[20:23], v[48:51]
    v_mfma_f32_16x16x32_bf16 v[48:51], v[112:115], v[24:27], v[48:51]
    v_mfma_f32_16x16x32_bf16 v[48:51], v[116:119], v[28:31], v[48:51]
    s_add_u32 m0, s43, 8192
    s_xor_b32 s66, s79, 68169728
    buffer_load_dwordx4 v2, s[4:7], s66 offen offset:0 nt lds
    buffer_load_dwordx4 v3, s[4:7], s66 offen offset:1024 nt lds
    buffer_load_dwordx4 v4, s[4:7], s66 offen offset:2048 nt lds
    buffer_load_dwordx4 v5, s[4:7], s66 offen offset:3072 nt lds
    s_waitcnt vmcnt(44)
    ds_read_b128 v[120:123], v6 offset:12288
    ds_read_b128 v[124:127], v7 offset:12288
    ds_read_b128 v[128:131], v8 offset:12288
    ds_read_b128 v[132:135], v9 offset:12288
    s_lshl_b64 s[52:53], s[58:59], 1
    v_cndmask_b32 v56, v56, v52, s[52:53]
    v_cndmask_b32 v57, v57, v53, s[52:53]
    v_cndmask_b32 v58, v58, v54, s[52:53]
    v_cndmask_b32 v59, v59, v55, s[52:53]
    s_waitcnt lgkmcnt(0)
    v_mfma_f32_16x16x32_bf16 v[52:55], v[120:123], v[16:19], 0
    v_mfma_f32_16x16x32_bf16 v[52:55], v[124:127], v[20:23], v[52:55]
    v_mfma_f32_16x16x32_bf16 v[52:55], v[128:131], v[24:27], v[52:55]
    v_mfma_f32_16x16x32_bf16 v[52:55], v[132:135], v[28:31], v[52:55]
    s_add_u32 m0, s43, 12288
    s_xor_b32 s66, s79, 68456448
    buffer_load_dwordx4 v2, s[4:7], s66 offen offset:0 nt lds
    buffer_load_dwordx4 v3, s[4:7], s66 offen offset:1024 nt lds
    buffer_load_dwordx4 v4, s[4:7], s66 offen offset:2048 nt lds
    buffer_load_dwordx4 v5, s[4:7], s66 offen offset:3072 nt lds
    s_waitcnt vmcnt(44)
    ds_read_b128 v[136:139], v6 offset:16384
    ds_read_b128 v[140:143], v7 offset:16384
    ds_read_b128 v[144:147], v8 offset:16384
    ds_read_b128 v[148:151], v9 offset:16384
    s_lshl_b64 s[52:53], s[58:59], 2
    v_cndmask_b32 v56, v56, v48, s[52:53]
    v_cndmask_b32 v57, v57, v49, s[52:53]
    v_cndmask_b32 v58, v58, v50, s[52:53]
    v_cndmask_b32 v59, v59, v51, s[52:53]
    s_waitcnt lgkmcnt(0)
    v_mfma_f32_16x16x32_bf16 v[48:51], v[136:139], v[16:19], 0
    v_mfma_f32_16x16x32_bf16 v[48:51], v[140:143], v[20:23], v[48:51]
    v_mfma_f32_16x16x32_bf16 v[48:51], v[144:147], v[24:27], v[48:51]
    v_mfma_f32_16x16x32_bf16 v[48:51], v[148:151], v[28:31], v[48:51]
    s_add_u32 m0, s43, 16384
    s_xor_b32 s66, s79, 69070848
    buffer_load_dwordx4 v2, s[4:7], s66 offen offset:0 nt lds
    buffer_load_dwordx4 v3, s[4:7], s66 offen offset:1024 nt lds
    buffer_load_dwordx4 v4, s[4:7], s66 offen offset:2048 nt lds
    buffer_load_dwordx4 v5, s[4:7], s66 offen offset:3072 nt lds
    s_waitcnt vmcnt(44)
    ds_read_b128 v[152:155], v6 offset:20480
    ds_read_b128 v[156:159], v7 offset:20480
    ds_read_b128 v[160:163], v8 offset:20480
    ds_read_b128 v[164:167], v9 offset:20480
    s_lshl_b64 s[52:53], s[58:59], 3
    v_cndmask_b32 v56, v56, v52, s[52:53]
    v_cndmask_b32 v57, v57, v53, s[52:53]
    v_cndmask_b32 v58, v58, v54, s[52:53]
    v_cndmask_b32 v59, v59, v55, s[52:53]
    s_waitcnt lgkmcnt(0)
    v_mfma_f32_16x16x32_bf16 v[52:55], v[152:155], v[16:19], 0
    v_mfma_f32_16x16x32_bf16 v[52:55], v[156:159], v[20:23], v[52:55]
    v_mfma_f32_16x16x32_bf16 v[52:55], v[160:163], v[24:27], v[52:55]
    v_mfma_f32_16x16x32_bf16 v[52:55], v[164:167], v[28:31], v[52:55]
    s_add_u32 m0, s43, 20480
    s_xor_b32 s66, s79, 68767744
    buffer_load_dwordx4 v2, s[4:7], s66 offen offset:0 nt lds
    buffer_load_dwordx4 v3, s[4:7], s66 offen offset:1024 nt lds
    buffer_load_dwordx4 v4, s[4:7], s66 offen offset:2048 nt lds
    buffer_load_dwordx4 v5, s[4:7], s66 offen offset:3072 nt lds
    s_waitcnt vmcnt(44)
    ds_read_b128 v[168:171], v6 offset:24576
    ds_read_b128 v[172:175], v7 offset:24576
    ds_read_b128 v[176:179], v8 offset:24576
    ds_read_b128 v[180:183], v9 offset:24576
    s_lshl_b64 s[52:53], s[58:59], 4
    v_cndmask_b32 v56, v56, v48, s[52:53]
    v_cndmask_b32 v57, v57, v49, s[52:53]
    v_cndmask_b32 v58, v58, v50, s[52:53]
    v_cndmask_b32 v59, v59, v51, s[52:53]
    s_waitcnt lgkmcnt(0)
    v_mfma_f32_16x16x32_bf16 v[48:51], v[168:171], v[16:19], 0
    v_mfma_f32_16x16x32_bf16 v[48:51], v[172:175], v[20:23], v[48:51]
    v_mfma_f32_16x16x32_bf16 v[48:51], v[176:179], v[24:27], v[48:51]
    v_mfma_f32_16x16x32_bf16 v[48:51], v[180:183], v[28:31], v[48:51]
    s_add_u32 m0, s43, 24576
    s_xor_b32 s66, s79, 68399104
    buffer_load_dwordx4 v2, s[4:7], s66 offen offset:0 nt lds
    buffer_load_dwordx4 v3, s[4:7], s66 offen offset:1024 nt lds
    buffer_load_dwordx4 v4, s[4:7], s66 offen offset:2048 nt lds
    buffer_load_dwordx4 v5, s[4:7], s66 offen offset:3072 nt lds
    s_waitcnt vmcnt(44)
    ds_read_b128 v[184:187], v6 offset:28672
    ds_read_b128 v[188:191], v7 offset:28672
    ds_read_b128 v[192:195], v8 offset:28672
    ds_read_b128 v[196:199], v9 offset:28672
    s_lshl_b64 s[52:53], s[58:59], 5
    v_cndmask_b32 v56, v56, v52, s[52:53]
    v_cndmask_b32 v57, v57, v53, s[52:53]
    v_cndmask_b32 v58, v58, v54, s[52:53]
    v_cndmask_b32 v59, v59, v55, s[52:53]
    s_waitcnt lgkmcnt(0)
    v_mfma_f32_16x16x32_bf16 v[52:55], v[184:187], v[16:19], 0
    v_mfma_f32_16x16x32_bf16 v[52:55], v[188:191], v[20:23], v[52:55]
    v_mfma_f32_16x16x32_bf16 v[52:55], v[192:195], v[24:27], v[52:55]
    v_mfma_f32_16x16x32_bf16 v[52:55], v[196:199], v[28:31], v[52:55]
    s_add_u32 m0, s43, 28672
    s_xor_b32 s66, s79, 68620288
    buffer_load_dwordx4 v2, s[4:7], s66 offen offset:0 nt lds
    buffer_load_dwordx4 v3, s[4:7], s66 offen offset:1024 nt lds
    buffer_load_dwordx4 v4, s[4:7], s66 offen offset:2048 nt lds
    buffer_load_dwordx4 v5, s[4:7], s66 offen offset:3072 nt lds
    s_mov_b32 s16, s22
    s_and_b32 s17, s23, 0xffff
    s_mov_b32 s18, 4194304
    s_mov_b32 s19, 0x20000
    s_mov_b32 s55, 1024
    s_and_b32 s56, s2, 7
    s_lshl_b32 s56, s56, 19
    s_lshl_b32 s57, s38, 17
    s_add_u32 s56, s56, s57
    s_lshr_b32 s57, s2, 3
    s_lshl_b32 s57, s57, 5
    s_add_u32 s56, s56, s57
    v_lshrrev_b32 v70, 1, v0
    v_mul_lo_u32 v70, v70, s55
    v_and_b32 v71, 1, v0
    v_lshl_add_u32 v70, v71, 4, v70
    s_lshl_b32 s57, s55, 5
    s_add_u32 m0, s44, 0
s_nop 0
    buffer_load_dwordx4 v70, s[16:19], s56 offen lds
    s_add_u32 m0, s44, 1024
    s_add_u32 s56, s56, s57
    buffer_load_dwordx4 v70, s[16:19], s56 offen lds
    s_add_u32 m0, s44, 2048
    s_add_u32 s56, s56, s57
    buffer_load_dwordx4 v70, s[16:19], s56 offen lds
    s_add_u32 m0, s44, 3072
    s_add_u32 s56, s56, s57
    buffer_load_dwordx4 v70, s[16:19], s56 offen lds
    s_waitcnt vmcnt(32)
    ds_read_b128 v[32:35], v6 offset:0
    ds_read_b128 v[36:39], v7 offset:0
    ds_read_b128 v[40:43], v8 offset:0
    ds_read_b128 v[44:47], v9 offset:0
    s_lshl_b64 s[52:53], s[58:59], 6
    v_cndmask_b32 v56, v56, v48, s[52:53]
    v_cndmask_b32 v57, v57, v49, s[52:53]
    v_cndmask_b32 v58, v58, v50, s[52:53]
    v_cndmask_b32 v59, v59, v51, s[52:53]
    s_waitcnt lgkmcnt(0)
    v_mfma_f32_16x16x32_bf16 v[48:51], v[32:35], v[16:19], 0
    v_mfma_f32_16x16x32_bf16 v[48:51], v[36:39], v[20:23], v[48:51]
    v_mfma_f32_16x16x32_bf16 v[48:51], v[40:43], v[24:27], v[48:51]
    v_mfma_f32_16x16x32_bf16 v[48:51], v[44:47], v[28:31], v[48:51]
    s_xor_b32 s67, s79, 67338240
    buffer_load_dwordx4 a[64:67], v1, s[8:11], s67 offen offset:0 nt
    buffer_load_dwordx4 a[68:71], v1, s[8:11], s67 offen offset:1024 nt
    buffer_load_dwordx4 a[72:75], v1, s[8:11], s67 offen offset:2048 nt
    buffer_load_dwordx4 a[76:79], v1, s[8:11], s67 offen offset:3072 nt
    s_xor_b32 s67, s79, 67575808
    buffer_load_dwordx4 a[80:83], v1, s[8:11], s67 offen offset:0 nt
    buffer_load_dwordx4 a[84:87], v1, s[8:11], s67 offen offset:1024 nt
    buffer_load_dwordx4 a[88:91], v1, s[8:11], s67 offen offset:2048 nt
    buffer_load_dwordx4 a[92:95], v1, s[8:11], s67 offen offset:3072 nt
    s_xor_b32 s67, s79, 68009984
    buffer_load_dwordx4 a[96:99], v1, s[8:11], s67 offen offset:0 nt
    buffer_load_dwordx4 a[100:103], v1, s[8:11], s67 offen offset:1024 nt
    buffer_load_dwordx4 a[104:107], v1, s[8:11], s67 offen offset:2048 nt
    buffer_load_dwordx4 a[108:111], v1, s[8:11], s67 offen offset:3072 nt
    s_xor_b32 s67, s79, 67723264
    buffer_load_dwordx4 a[112:115], v1, s[8:11], s67 offen offset:0 nt
    buffer_load_dwordx4 a[116:119], v1, s[8:11], s67 offen offset:1024 nt
    buffer_load_dwordx4 a[120:123], v1, s[8:11], s67 offen offset:2048 nt
    buffer_load_dwordx4 a[124:127], v1, s[8:11], s67 offen offset:3072 nt
    s_xor_b32 s67, s79, 69103616
    buffer_load_dwordx4 a[128:131], v1, s[8:11], s67 offen offset:0 nt
    buffer_load_dwordx4 a[132:135], v1, s[8:11], s67 offen offset:1024 nt
    buffer_load_dwordx4 a[136:139], v1, s[8:11], s67 offen offset:2048 nt
    buffer_load_dwordx4 a[140:143], v1, s[8:11], s67 offen offset:3072 nt
    s_waitcnt vmcnt(48)
    ds_read_b128 v[32:35], v6 offset:4096
    ds_read_b128 v[36:39], v7 offset:4096
    ds_read_b128 v[40:43], v8 offset:4096
    ds_read_b128 v[44:47], v9 offset:4096
    s_lshl_b64 s[52:53], s[58:59], 7
    v_cndmask_b32 v56, v56, v52, s[52:53]
    v_cndmask_b32 v57, v57, v53, s[52:53]
    v_cndmask_b32 v58, v58, v54, s[52:53]
    v_cndmask_b32 v59, v59, v55, s[52:53]
    s_waitcnt lgkmcnt(0)
    v_mfma_f32_16x16x32_bf16 v[52:55], v[32:35], v[16:19], 0
    v_mfma_f32_16x16x32_bf16 v[52:55], v[36:39], v[20:23], v[52:55]
    v_mfma_f32_16x16x32_bf16 v[52:55], v[40:43], v[24:27], v[52:55]
    v_mfma_f32_16x16x32_bf16 v[52:55], v[44:47], v[28:31], v[52:55]
    s_xor_b32 s67, s79, 68866048
    buffer_load_dwordx4 a[144:147], v1, s[8:11], s67 offen offset:0 nt
    buffer_load_dwordx4 a[148:151], v1, s[8:11], s67 offen offset:1024 nt
    buffer_load_dwordx4 a[152:155], v1, s[8:11], s67 offen offset:2048 nt
    buffer_load_dwordx4 a[156:159], v1, s[8:11], s67 offen offset:3072 nt
    s_waitcnt vmcnt(48)
    ds_read_b128 v[32:35], v6 offset:8192
    ds_read_b128 v[36:39], v7 offset:8192
    ds_read_b128 v[40:43], v8 offset:8192
    ds_read_b128 v[44:47], v9 offset:8192
    s_lshl_b64 s[52:53], s[58:59], 8
    v_cndmask_b32 v56, v56, v48, s[52:53]
    v_cndmask_b32 v57, v57, v49, s[52:53]
    v_cndmask_b32 v58, v58, v50, s[52:53]
    v_cndmask_b32 v59, v59, v51, s[52:53]
    s_waitcnt lgkmcnt(0)
    v_mfma_f32_16x16x32_bf16 v[48:51], v[32:35], v[16:19], 0
    v_mfma_f32_16x16x32_bf16 v[48:51], v[36:39], v[20:23], v[48:51]
    v_mfma_f32_16x16x32_bf16 v[48:51], v[40:43], v[24:27], v[48:51]
    v_mfma_f32_16x16x32_bf16 v[48:51], v[44:47], v[28:31], v[48:51]
    s_xor_b32 s67, s79, 68169728
    buffer_load_dwordx4 a[160:163], v1, s[8:11], s67 offen offset:0 nt
    buffer_load_dwordx4 a[164:167], v1, s[8:11], s67 offen offset:1024 nt
    buffer_load_dwordx4 a[168:171], v1, s[8:11], s67 offen offset:2048 nt
    buffer_load_dwordx4 a[172:175], v1, s[8:11], s67 offen offset:3072 nt
    s_waitcnt vmcnt(48)
    ds_read_b128 v[32:35], v6 offset:12288
    ds_read_b128 v[36:39], v7 offset:12288
    ds_read_b128 v[40:43], v8 offset:12288
    ds_read_b128 v[44:47], v9 offset:12288
    s_lshl_b64 s[52:53], s[58:59], 9
    v_cndmask_b32 v56, v56, v52, s[52:53]
    v_cndmask_b32 v57, v57, v53, s[52:53]
    v_cndmask_b32 v58, v58, v54, s[52:53]
    v_cndmask_b32 v59, v59, v55, s[52:53]
    s_waitcnt lgkmcnt(0)
    v_mfma_f32_16x16x32_bf16 v[52:55], v[32:35], v[16:19], 0
    v_mfma_f32_16x16x32_bf16 v[52:55], v[36:39], v[20:23], v[52:55]
    v_mfma_f32_16x16x32_bf16 v[52:55], v[40:43], v[24:27], v[52:55]
    v_mfma_f32_16x16x32_bf16 v[52:55], v[44:47], v[28:31], v[52:55]
    s_xor_b32 s67, s79, 68456448
    buffer_load_dwordx4 a[176:179], v1, s[8:11], s67 offen offset:0 nt
    buffer_load_dwordx4 a[180:183], v1, s[8:11], s67 offen offset:1024 nt
    buffer_load_dwordx4 a[184:187], v1, s[8:11], s67 offen offset:2048 nt
    buffer_load_dwordx4 a[188:191], v1, s[8:11], s67 offen offset:3072 nt
    s_waitcnt vmcnt(48)
    ds_read_b128 v[32:35], v6 offset:16384
    ds_read_b128 v[36:39], v7 offset:16384
    ds_read_b128 v[40:43], v8 offset:16384
    ds_read_b128 v[44:47], v9 offset:16384
    s_lshl_b64 s[52:53], s[58:59], 10
    v_cndmask_b32 v56, v56, v48, s[52:53]
    v_cndmask_b32 v57, v57, v49, s[52:53]
    v_cndmask_b32 v58, v58, v50, s[52:53]
    v_cndmask_b32 v59, v59, v51, s[52:53]
    s_waitcnt lgkmcnt(0)
    v_mfma_f32_16x16x32_bf16 v[48:51], v[32:35], v[16:19], 0
    v_mfma_f32_16x16x32_bf16 v[48:51], v[36:39], v[20:23], v[48:51]
    v_mfma_f32_16x16x32_bf16 v[48:51], v[40:43], v[24:27], v[48:51]
    v_mfma_f32_16x16x32_bf16 v[48:51], v[44:47], v[28:31], v[48:51]
    s_xor_b32 s67, s79, 69070848
    buffer_load_dwordx4 a[192:195], v1, s[8:11], s67 offen offset:0 nt
    buffer_load_dwordx4 a[196:199], v1, s[8:11], s67 offen offset:1024 nt
    buffer_load_dwordx4 a[200:203], v1, s[8:11], s67 offen offset:2048 nt
    buffer_load_dwordx4 a[204:207], v1, s[8:11], s67 offen offset:3072 nt
    s_waitcnt vmcnt(48)
    ds_read_b128 v[32:35], v6 offset:20480
    ds_read_b128 v[36:39], v7 offset:20480
    ds_read_b128 v[40:43], v8 offset:20480
    ds_read_b128 v[44:47], v9 offset:20480
    s_lshl_b64 s[52:53], s[58:59], 11
    v_cndmask_b32 v56, v56, v52, s[52:53]
    v_cndmask_b32 v57, v57, v53, s[52:53]
    v_cndmask_b32 v58, v58, v54, s[52:53]
    v_cndmask_b32 v59, v59, v55, s[52:53]
    s_waitcnt lgkmcnt(0)
    v_mfma_f32_16x16x32_bf16 v[52:55], v[32:35], v[16:19], 0
    v_mfma_f32_16x16x32_bf16 v[52:55], v[36:39], v[20:23], v[52:55]
    v_mfma_f32_16x16x32_bf16 v[52:55], v[40:43], v[24:27], v[52:55]
    v_mfma_f32_16x16x32_bf16 v[52:55], v[44:47], v[28:31], v[52:55]
    s_xor_b32 s67, s79, 68767744
    buffer_load_dwordx4 a[208:211], v1, s[8:11], s67 offen offset:0 nt
    buffer_load_dwordx4 a[212:215], v1, s[8:11], s67 offen offset:1024 nt
    buffer_load_dwordx4 a[216:219], v1, s[8:11], s67 offen offset:2048 nt
    buffer_load_dwordx4 a[220:223], v1, s[8:11], s67 offen offset:3072 nt
    s_waitcnt vmcnt(48)
    ds_read_b128 v[32:35], v6 offset:24576
    ds_read_b128 v[36:39], v7 offset:24576
    ds_read_b128 v[40:43], v8 offset:24576
    ds_read_b128 v[44:47], v9 offset:24576
    s_lshl_b64 s[52:53], s[58:59], 12
    v_cndmask_b32 v56, v56, v48, s[52:53]
    v_cndmask_b32 v57, v57, v49, s[52:53]
    v_cndmask_b32 v58, v58, v50, s[52:53]
    v_cndmask_b32 v59, v59, v51, s[52:53]
    s_waitcnt lgkmcnt(0)
    v_mfma_f32_16x16x32_bf16 v[48:51], v[32:35], v[16:19], 0
    v_mfma_f32_16x16x32_bf16 v[48:51], v[36:39], v[20:23], v[48:51]
    v_mfma_f32_16x16x32_bf16 v[48:51], v[40:43], v[24:27], v[48:51]
    v_mfma_f32_16x16x32_bf16 v[48:51], v[44:47], v[28:31], v[48:51]
    s_xor_b32 s67, s79, 68399104
    buffer_load_dwordx4 a[224:227], v1, s[8:11], s67 offen offset:0 nt
    buffer_load_dwordx4 a[228:231], v1, s[8:11], s67 offen offset:1024 nt
    buffer_load_dwordx4 a[232:235], v1, s[8:11], s67 offen offset:2048 nt
    buffer_load_dwordx4 a[236:239], v1, s[8:11], s67 offen offset:3072 nt
    s_waitcnt vmcnt(48)
    ds_read_b128 v[32:35], v6 offset:28672
    ds_read_b128 v[36:39], v7 offset:28672
    ds_read_b128 v[40:43], v8 offset:28672
    ds_read_b128 v[44:47], v9 offset:28672
    s_lshl_b64 s[52:53], s[58:59], 13
    v_cndmask_b32 v56, v56, v52, s[52:53]
    v_cndmask_b32 v57, v57, v53, s[52:53]
    v_cndmask_b32 v58, v58, v54, s[52:53]
    v_cndmask_b32 v59, v59, v55, s[52:53]
    s_waitcnt lgkmcnt(0)
    v_mfma_f32_16x16x32_bf16 v[52:55], v[32:35], v[16:19], 0
    v_mfma_f32_16x16x32_bf16 v[52:55], v[36:39], v[20:23], v[52:55]
    v_mfma_f32_16x16x32_bf16 v[52:55], v[40:43], v[24:27], v[52:55]
    v_mfma_f32_16x16x32_bf16 v[52:55], v[44:47], v[28:31], v[52:55]
    s_xor_b32 s67, s79, 68620288
    buffer_load_dwordx4 a[240:243], v1, s[8:11], s67 offen offset:0 nt
    buffer_load_dwordx4 a[244:247], v1, s[8:11], s67 offen offset:1024 nt
    buffer_load_dwordx4 a[248:251], v1, s[8:11], s67 offen offset:2048 nt
    buffer_load_dwordx4 a[252:255], v1, s[8:11], s67 offen offset:3072 nt
    s_lshl_b64 s[52:53], s[58:59], 14
    v_cndmask_b32 v56, v56, v48, s[52:53]
    v_cndmask_b32 v57, v57, v49, s[52:53]
    v_cndmask_b32 v58, v58, v50, s[52:53]
    v_cndmask_b32 v59, v59, v51, s[52:53]
    s_lshl_b64 s[52:53], s[58:59], 15
    v_cndmask_b32 v56, v56, v52, s[52:53]
    v_cndmask_b32 v57, v57, v53, s[52:53]
    v_cndmask_b32 v58, v58, v54, s[52:53]
    v_cndmask_b32 v59, v59, v55, s[52:53]
    v_max3_f32 v70, v56, v57, v58
    v_max_f32 v70, v70, v59
s_nop 1
    v_max_f32_dpp v70, v70, v70 row_ror:8 row_mask:0xf bank_mask:0xf
s_nop 1
    v_max_f32_dpp v70, v70, v70 row_ror:4 row_mask:0xf bank_mask:0xf
s_nop 1
    v_max_f32_dpp v70, v70, v70 row_ror:2 row_mask:0xf bank_mask:0xf
s_nop 1
    v_max_f32_dpp v70, v70, v70 row_ror:1 row_mask:0xf bank_mask:0xf
    v_mov_b32 v71, v70
s_nop 1
    v_permlane16_swap_b32 v71, v70
    v_max_f32 v70, v71, v70
    v_mov_b32 v71, v70
s_nop 1
    v_permlane32_swap_b32 v71, v70
    v_max_f32 v70, v71, v70
    v_mov_b32 v68, v70
    v_mul_f32 v70, s60, v68
    v_fma_f32 v56, v56, s60, -v70
    v_fma_f32 v57, v57, s60, -v70
    v_fma_f32 v58, v58, s60, -v70
    v_fma_f32 v59, v59, s60, -v70
    v_exp_f32 v56, v56
    v_exp_f32 v57, v57
    v_exp_f32 v58, v58
    v_exp_f32 v59, v59
    v_cvt_pk_bf16_f32 v48, v56, v56
    v_cvt_pk_bf16_f32 v49, v57, v57
    v_cvt_pk_bf16_f32 v50, v58, v58
    v_cvt_pk_bf16_f32 v51, v59, v59
    ds_write_b32 v14, v48 offset:0
    ds_write_b32 v14, v49 offset:144
    ds_write_b32 v14, v50 offset:288
    ds_write_b32 v14, v51 offset:432
    v_add_f32 v56, v56, v57
    v_add_f32 v58, v58, v59
    v_add_f32 v56, v56, v58
    v_mov_b32 v69, v56
    s_waitcnt lgkmcnt(0)
    ds_read_b128 v[40:43], v15 offset:0
    s_waitcnt lgkmcnt(0)
    ds_read_b128 v[44:47], v15 offset:16
    v_and_b32 v32, v40, v10
    v_and_b32 v33, v40, v11
    v_and_b32 v34, v40, v12
    v_and_b32 v35, v40, v13
    s_waitcnt vmcnt(48)
    v_lshrrev_b32 v70, 4, v0
    v_lshlrev_b32 v70, 3, v70
    v_bfe_u32 v71, v0, 2, 2
    v_add_u32 v70, v70, v71
    v_lshlrev_b32 v70, 5, v70
    v_and_b32 v71, 3, v0
    v_lshl_add_u32 v70, v71, 3, v70
    v_add_u32 v70, s44, v70
    ds_read_b64_tr_b16 v[16:17], v70 offset:0
    ds_read_b64_tr_b16 v[18:19], v70 offset:128
    ds_read_b64_tr_b16 v[20:21], v70 offset:1024
    ds_read_b64_tr_b16 v[22:23], v70 offset:1152
    ds_read_b64_tr_b16 v[24:25], v70 offset:2048
    ds_read_b64_tr_b16 v[26:27], v70 offset:2176
    ds_read_b64_tr_b16 v[28:29], v70 offset:3072
    ds_read_b64_tr_b16 v[30:31], v70 offset:3200
    v_add_f32_dpp v69, v69, v69 row_ror:8 row_mask:0xf bank_mask:0xf
s_nop 1
    v_add_f32_dpp v69, v69, v69 row_ror:4 row_mask:0xf bank_mask:0xf
s_nop 1
    v_add_f32_dpp v69, v69, v69 row_ror:2 row_mask:0xf bank_mask:0xf
s_nop 1
    v_add_f32_dpp v69, v69, v69 row_ror:1 row_mask:0xf bank_mask:0xf
    v_mov_b32 v70, v69
s_nop 1
    v_permlane16_swap_b32 v70, v69
    v_add_f32 v69, v70, v69
    v_mov_b32 v70, v69
s_nop 1
    v_permlane32_swap_b32 v70, v69
    v_add_f32 v69, v70, v69
    s_lshl_b32 s54, s38, 3
    s_add_u32 s54, s54, 156160
    v_mov_b32 v70, s54
    ds_write_b64 v70, v[68:69]
    s_waitcnt lgkmcnt(0)
    s_cmp_lt_u32 s2, 112
    s_cbranch_scc1 Ls2_22
    s_mov_b32 s16, s20
    s_and_b32 s17, s21, 0xffff
    s_mov_b32 s18, 4194304
    s_mov_b32 s19, 0x20000
    s_mov_b32 s55, 8192
    s_lshr_b32 s56, s40, 1
    s_lshl_b32 s56, s56, 20
    s_lshl_b32 s57, s39, 8
    s_add_u32 s56, s56, s57
    s_and_b32 s57, s40, 1
    s_lshl_b32 s57, s57, 7
    s_add_u32 s56, s56, s57
    s_lshl_b32 s57, s38, 5
    s_add_u32 s56, s56, s57
    s_branch Ls2j_23
Ls2_22:
    s_mov_b32 s16, s24
    s_and_b32 s17, s25, 0xffff
    s_mov_b32 s18, 1835008
    s_mov_b32 s19, 0x20000
    s_mov_b32 s55, 3584
    s_mul_i32 s56, s38, 458752
    s_lshl_b32 s57, s2, 5
    s_add_u32 s56, s56, s57
Ls2j_23:
    v_lshrrev_b32 v70, 1, v0
    v_mul_lo_u32 v70, v70, s55
    v_and_b32 v71, 1, v0
    v_lshl_add_u32 v70, v71, 4, v70
    s_lshl_b32 s57, s55, 5
    s_add_u32 m0, s44, 0
s_nop 0
    buffer_load_dwordx4 v70, s[16:19], s56 offen lds
    s_add_u32 m0, s44, 1024
    s_add_u32 s56, s56, s57
    buffer_load_dwordx4 v70, s[16:19], s56 offen lds
    s_add_u32 m0, s44, 2048
    s_add_u32 s56, s56, s57
    buffer_load_dwordx4 v70, s[16:19], s56 offen lds
    s_add_u32 m0, s44, 3072
    s_add_u32 s56, s56, s57
    buffer_load_dwordx4 v70, s[16:19], s56 offen lds
    v_and_b32 v36, v41, v10
    v_and_b32 v37, v41, v11
    v_mfma_f32_16x16x32_bf16 v[60:63], a[0:3], v[32:35], 0
    v_and_b32 v38, v41, v12
    v_and_b32 v39, v41, v13
    v_mfma_f32_16x16x32_bf16 v[64:67], a[4:7], v[32:35], 0
    v_and_b32 v32, v42, v10
    v_and_b32 v33, v42, v11
    v_mfma_f32_16x16x32_bf16 v[60:63], a[8:11], v[36:39], v[60:63]
    v_and_b32 v34, v42, v12
    v_and_b32 v35, v42, v13
    v_mfma_f32_16x16x32_bf16 v[64:67], a[12:15], v[36:39], v[64:67]
    v_and_b32 v36, v43, v10
    v_and_b32 v37, v43, v11
    v_mfma_f32_16x16x32_bf16 v[60:63], a[16:19], v[32:35], v[60:63]
    v_and_b32 v38, v43, v12
    v_and_b32 v39, v43, v13
    v_mfma_f32_16x16x32_bf16 v[64:67], a[20:23], v[32:35], v[64:67]
    s_waitcnt lgkmcnt(9)
    v_and_b32 v32, v44, v10
    v_and_b32 v33, v44, v11
    v_mfma_f32_16x16x32_bf16 v[60:63], a[24:27], v[36:39], v[60:63]
    v_and_b32 v34, v44, v12
    v_and_b32 v35, v44, v13
    v_mfma_f32_16x16x32_bf16 v[64:67], a[28:31], v[36:39], v[64:67]
    ds_read_b128 v[40:43], v15 offset:32
    v_and_b32 v36, v45, v10
    v_and_b32 v37, v45, v11
    v_mfma_f32_16x16x32_bf16 v[60:63], a[32:35], v[32:35], v[60:63]
    v_and_b32 v38, v45, v12
    v_and_b32 v39, v45, v13
    v_mfma_f32_16x16x32_bf16 v[64:67], a[36:39], v[32:35], v[64:67]
    v_and_b32 v32, v46, v10
    v_and_b32 v33, v46, v11
    v_mfma_f32_16x16x32_bf16 v[60:63], a[40:43], v[36:39], v[60:63]
    v_and_b32 v34, v46, v12
    v_and_b32 v35, v46, v13
    v_mfma_f32_16x16x32_bf16 v[64:67], a[44:47], v[36:39], v[64:67]
    v_and_b32 v36, v47, v10
    v_and_b32 v37, v47, v11
    v_mfma_f32_16x16x32_bf16 v[60:63], a[48:51], v[32:35], v[60:63]
    v_and_b32 v38, v47, v12
    v_and_b32 v39, v47, v13
    v_mfma_f32_16x16x32_bf16 v[64:67], a[52:55], v[32:35], v[64:67]
    s_waitcnt lgkmcnt(0)
    v_and_b32 v32, v40, v10
    v_and_b32 v33, v40, v11
    v_mfma_f32_16x16x32_bf16 v[60:63], a[56:59], v[36:39], v[60:63]
    v_and_b32 v34, v40, v12
    v_and_b32 v35, v40, v13
    v_mfma_f32_16x16x32_bf16 v[64:67], a[60:63], v[36:39], v[64:67]
    ds_read_b128 v[44:47], v15 offset:48
    s_waitcnt vmcnt(51)
    v_and_b32 v36, v41, v10
    v_and_b32 v37, v41, v11
    v_mfma_f32_16x16x32_bf16 v[60:63], a[64:67], v[32:35], v[60:63]
    s_waitcnt vmcnt(50)
    v_and_b32 v38, v41, v12
    v_and_b32 v39, v41, v13
    v_mfma_f32_16x16x32_bf16 v[64:67], a[68:71], v[32:35], v[64:67]
    s_waitcnt vmcnt(49)
    v_and_b32 v32, v42, v10
    v_and_b32 v33, v42, v11
    v_mfma_f32_16x16x32_bf16 v[60:63], a[72:75], v[36:39], v[60:63]
    s_waitcnt vmcnt(48)
    v_and_b32 v34, v42, v12
    v_and_b32 v35, v42, v13
    v_mfma_f32_16x16x32_bf16 v[64:67], a[76:79], v[36:39], v[64:67]
    s_waitcnt vmcnt(47)
    v_and_b32 v36, v43, v10
    v_and_b32 v37, v43, v11
    v_mfma_f32_16x16x32_bf16 v[60:63], a[80:83], v[32:35], v[60:63]
    s_waitcnt vmcnt(46)
    v_and_b32 v38, v43, v12
    v_and_b32 v39, v43, v13
    v_mfma_f32_16x16x32_bf16 v[64:67], a[84:87], v[32:35], v[64:67]
    s_waitcnt lgkmcnt(0)
    s_waitcnt vmcnt(45)
    v_and_b32 v32, v44, v10
    v_and_b32 v33, v44, v11
    v_mfma_f32_16x16x32_bf16 v[60:63], a[88:91], v[36:39], v[60:63]
    s_waitcnt vmcnt(44)
    v_and_b32 v34, v44, v12
    v_and_b32 v35, v44, v13
    v_mfma_f32_16x16x32_bf16 v[64:67], a[92:95], v[36:39], v[64:67]
    ds_read_b128 v[40:43], v15 offset:64
    s_waitcnt vmcnt(43)
    v_and_b32 v36, v45, v10
    v_and_b32 v37, v45, v11
    v_mfma_f32_16x16x32_bf16 v[60:63], a[96:99], v[32:35], v[60:63]
    s_waitcnt vmcnt(42)
    v_and_b32 v38, v45, v12
    v_and_b32 v39, v45, v13
    v_mfma_f32_16x16x32_bf16 v[64:67], a[100:103], v[32:35], v[64:67]
    s_waitcnt vmcnt(41)
    v_and_b32 v32, v46, v10
    v_and_b32 v33, v46, v11
    v_mfma_f32_16x16x32_bf16 v[60:63], a[104:107], v[36:39], v[60:63]
    s_waitcnt vmcnt(40)
    v_and_b32 v34, v46, v12
    v_and_b32 v35, v46, v13
    v_mfma_f32_16x16x32_bf16 v[64:67], a[108:111], v[36:39], v[64:67]
    s_waitcnt vmcnt(39)
    v_and_b32 v36, v47, v10
    v_and_b32 v37, v47, v11
    v_mfma_f32_16x16x32_bf16 v[60:63], a[112:115], v[32:35], v[60:63]
    s_waitcnt vmcnt(38)
    v_and_b32 v38, v47, v12
    v_and_b32 v39, v47, v13
    v_mfma_f32_16x16x32_bf16 v[64:67], a[116:119], v[32:35], v[64:67]
    s_waitcnt lgkmcnt(0)
    s_waitcnt vmcnt(37)
    v_and_b32 v32, v40, v10
    v_and_b32 v33, v40, v11
    v_mfma_f32_16x16x32_bf16 v[60:63], a[120:123], v[36:39], v[60:63]
    s_waitcnt vmcnt(36)
    v_and_b32 v34, v40, v12
    v_and_b32 v35, v40, v13
    v_mfma_f32_16x16x32_bf16 v[64:67], a[124:127], v[36:39], v[64:67]
    ds_read_b128 v[44:47], v15 offset:80
    s_waitcnt vmcnt(35)
    v_and_b32 v36, v41, v10
    v_and_b32 v37, v41, v11
    v_mfma_f32_16x16x32_bf16 v[60:63], a[128:131], v[32:35], v[60:63]
    s_waitcnt vmcnt(34)
    v_and_b32 v38, v41, v12
    v_and_b32 v39, v41, v13
    v_mfma_f32_16x16x32_bf16 v[64:67], a[132:135], v[32:35], v[64:67]
    s_waitcnt vmcnt(33)
    v_and_b32 v32, v42, v10
    v_and_b32 v33, v42, v11
    v_mfma_f32_16x16x32_bf16 v[60:63], a[136:139], v[36:39], v[60:63]
    s_waitcnt vmcnt(32)
    v_and_b32 v34, v42, v12
    v_and_b32 v35, v42, v13
    v_mfma_f32_16x16x32_bf16 v[64:67], a[140:143], v[36:39], v[64:67]
    s_waitcnt vmcnt(31)
    v_and_b32 v36, v43, v10
    v_and_b32 v37, v43, v11
    v_mfma_f32_16x16x32_bf16 v[60:63], a[144:147], v[32:35], v[60:63]
    s_waitcnt vmcnt(30)
    v_and_b32 v38, v43, v12
    v_and_b32 v39, v43, v13
    v_mfma_f32_16x16x32_bf16 v[64:67], a[148:151], v[32:35], v[64:67]
    s_waitcnt lgkmcnt(0)
    s_waitcnt vmcnt(29)
    v_and_b32 v32, v44, v10
    v_and_b32 v33, v44, v11
    v_mfma_f32_16x16x32_bf16 v[60:63], a[152:155], v[36:39], v[60:63]
    s_waitcnt vmcnt(28)
    v_and_b32 v34, v44, v12
    v_and_b32 v35, v44, v13
    v_mfma_f32_16x16x32_bf16 v[64:67], a[156:159], v[36:39], v[64:67]
    ds_read_b128 v[40:43], v15 offset:96
    s_waitcnt vmcnt(27)
    v_and_b32 v36, v45, v10
    v_and_b32 v37, v45, v11
    v_mfma_f32_16x16x32_bf16 v[60:63], a[160:163], v[32:35], v[60:63]
    s_waitcnt vmcnt(26)
    v_and_b32 v38, v45, v12
    v_and_b32 v39, v45, v13
    v_mfma_f32_16x16x32_bf16 v[64:67], a[164:167], v[32:35], v[64:67]
    s_waitcnt vmcnt(25)
    v_and_b32 v32, v46, v10
    v_and_b32 v33, v46, v11
    v_mfma_f32_16x16x32_bf16 v[60:63], a[168:171], v[36:39], v[60:63]
    s_waitcnt vmcnt(24)
    v_and_b32 v34, v46, v12
    v_and_b32 v35, v46, v13
    v_mfma_f32_16x16x32_bf16 v[64:67], a[172:175], v[36:39], v[64:67]
    s_waitcnt vmcnt(23)
    v_and_b32 v36, v47, v10
    v_and_b32 v37, v47, v11
    v_mfma_f32_16x16x32_bf16 v[60:63], a[176:179], v[32:35], v[60:63]
    s_waitcnt vmcnt(22)
    v_and_b32 v38, v47, v12
    v_and_b32 v39, v47, v13
    v_mfma_f32_16x16x32_bf16 v[64:67], a[180:183], v[32:35], v[64:67]
    s_waitcnt lgkmcnt(0)
    s_waitcnt vmcnt(21)
    v_and_b32 v32, v40, v10
    v_and_b32 v33, v40, v11
    v_mfma_f32_16x16x32_bf16 v[60:63], a[184:187], v[36:39], v[60:63]
    s_waitcnt vmcnt(20)
    v_and_b32 v34, v40, v12
    v_and_b32 v35, v40, v13
    v_mfma_f32_16x16x32_bf16 v[64:67], a[188:191], v[36:39], v[64:67]
    ds_read_b128 v[44:47], v15 offset:112
    s_waitcnt vmcnt(19)
    v_and_b32 v36, v41, v10
    v_and_b32 v37, v41, v11
    v_mfma_f32_16x16x32_bf16 v[60:63], a[192:195], v[32:35], v[60:63]
    s_waitcnt vmcnt(18)
    v_and_b32 v38, v41, v12
    v_and_b32 v39, v41, v13
    v_mfma_f32_16x16x32_bf16 v[64:67], a[196:199], v[32:35], v[64:67]
    s_waitcnt vmcnt(17)
    v_and_b32 v32, v42, v10
    v_and_b32 v33, v42, v11
    v_mfma_f32_16x16x32_bf16 v[60:63], a[200:203], v[36:39], v[60:63]
    s_waitcnt vmcnt(16)
    v_and_b32 v34, v42, v12
    v_and_b32 v35, v42, v13
    v_mfma_f32_16x16x32_bf16 v[64:67], a[204:207], v[36:39], v[64:67]
    s_waitcnt vmcnt(15)
    v_and_b32 v36, v43, v10
    v_and_b32 v37, v43, v11
    v_mfma_f32_16x16x32_bf16 v[60:63], a[208:211], v[32:35], v[60:63]
    s_waitcnt vmcnt(14)
    v_and_b32 v38, v43, v12
    v_and_b32 v39, v43, v13
    v_mfma_f32_16x16x32_bf16 v[64:67], a[212:215], v[32:35], v[64:67]
    s_waitcnt lgkmcnt(0)
    s_waitcnt vmcnt(13)
    v_and_b32 v32, v44, v10
    v_and_b32 v33, v44, v11
    v_mfma_f32_16x16x32_bf16 v[60:63], a[216:219], v[36:39], v[60:63]
    s_waitcnt vmcnt(12)
    v_and_b32 v34, v44, v12
    v_and_b32 v35, v44, v13
    v_mfma_f32_16x16x32_bf16 v[64:67], a[220:223], v[36:39], v[64:67]
    s_waitcnt vmcnt(11)
    v_and_b32 v36, v45, v10
    v_and_b32 v37, v45, v11
    v_mfma_f32_16x16x32_bf16 v[60:63], a[224:227], v[32:35], v[60:63]
    s_waitcnt vmcnt(10)
    v_and_b32 v38, v45, v12
    v_and_b32 v39, v45, v13
    v_mfma_f32_16x16x32_bf16 v[64:67], a[228:231], v[32:35], v[64:67]
    s_waitcnt vmcnt(9)
    v_and_b32 v32, v46, v10
    v_and_b32 v33, v46, v11
    v_mfma_f32_16x16x32_bf16 v[60:63], a[232:235], v[36:39], v[60:63]
    s_waitcnt vmcnt(8)
    v_and_b32 v34, v46, v12
    v_and_b32 v35, v46, v13
    v_mfma_f32_16x16x32_bf16 v[64:67], a[236:239], v[36:39], v[64:67]
    s_waitcnt vmcnt(7)
    v_and_b32 v36, v47, v10
    v_and_b32 v37, v47, v11
    v_mfma_f32_16x16x32_bf16 v[60:63], a[240:243], v[32:35], v[60:63]
    s_waitcnt vmcnt(6)
    v_and_b32 v38, v47, v12
    v_and_b32 v39, v47, v13
    v_mfma_f32_16x16x32_bf16 v[64:67], a[244:247], v[32:35], v[64:67]
    s_waitcnt vmcnt(5)
    v_mfma_f32_16x16x32_bf16 v[60:63], a[248:251], v[36:39], v[60:63]
    s_waitcnt vmcnt(4)
    v_mfma_f32_16x16x32_bf16 v[64:67], a[252:255], v[36:39], v[64:67]
    s_branch L_TAIL
L_S3:
    ds_read_b128 v[32:35], v6 offset:0
    ds_read_b128 v[36:39], v7 offset:0
    ds_read_b128 v[40:43], v8 offset:0
    ds_read_b128 v[44:47], v9 offset:0
    s_waitcnt lgkmcnt(0)
    v_mfma_f32_16x16x32_bf16 v[48:51], v[32:35], v[16:19], 0
    v_mfma_f32_16x16x32_bf16 v[48:51], v[36:39], v[20:23], v[48:51]
    v_mfma_f32_16x16x32_bf16 v[48:51], v[40:43], v[24:27], v[48:51]
    v_mfma_f32_16x16x32_bf16 v[48:51], v[44:47], v[28:31], v[48:51]
    s_mov_b32 s16, s22
    s_and_b32 s17, s23, 0xffff
    s_mov_b32 s18, 4194304
    s_mov_b32 s19, 0x20000
    s_mov_b32 s55, 1024
    s_and_b32 s56, s2, 7
    s_lshl_b32 s56, s56, 19
    s_lshl_b32 s57, s38, 17
    s_add_u32 s56, s56, s57
    s_lshr_b32 s57, s2, 3
    s_lshl_b32 s57, s57, 5
    s_add_u32 s56, s56, s57
    v_lshrrev_b32 v70, 1, v0
    v_mul_lo_u32 v70, v70, s55
    v_and_b32 v71, 1, v0
    v_lshl_add_u32 v70, v71, 4, v70
    s_lshl_b32 s57, s55, 5
    s_add_u32 m0, s44, 0
s_nop 0
    buffer_load_dwordx4 v70, s[16:19], s56 offen lds
    s_add_u32 m0, s44, 1024
    s_add_u32 s56, s56, s57
    buffer_load_dwordx4 v70, s[16:19], s56 offen lds
    s_add_u32 m0, s44, 2048
    s_add_u32 s56, s56, s57
    buffer_load_dwordx4 v70, s[16:19], s56 offen lds
    s_add_u32 m0, s44, 3072
    s_add_u32 s56, s56, s57
    buffer_load_dwordx4 v70, s[16:19], s56 offen lds
    s_waitcnt lgkmcnt(0)
    ds_read_b128 v[32:35], v6 offset:4096
    ds_read_b128 v[36:39], v7 offset:4096
    ds_read_b128 v[40:43], v8 offset:4096
    ds_read_b128 v[44:47], v9 offset:4096
    v_mfma_f32_16x16x32_bf16 v[52:55], v[72:75], v[16:19], 0
    v_mfma_f32_16x16x32_bf16 v[52:55], v[76:79], v[20:23], v[52:55]
    v_mfma_f32_16x16x32_bf16 v[52:55], v[80:83], v[24:27], v[52:55]
    v_mfma_f32_16x16x32_bf16 v[52:55], v[84:87], v[28:31], v[52:55]
    s_lshl_b64 s[52:53], s[58:59], 8
    v_cndmask_b32 v56, v56, v48, s[52:53]
    v_cndmask_b32 v57, v57, v49, s[52:53]
    v_cndmask_b32 v58, v58, v50, s[52:53]
    v_cndmask_b32 v59, v59, v51, s[52:53]
    s_waitcnt lgkmcnt(0)
    v_mfma_f32_16x16x32_bf16 v[48:51], v[32:35], v[16:19], 0
    v_mfma_f32_16x16x32_bf16 v[48:51], v[36:39], v[20:23], v[48:51]
    v_mfma_f32_16x16x32_bf16 v[48:51], v[40:43], v[24:27], v[48:51]
    v_mfma_f32_16x16x32_bf16 v[48:51], v[44:47], v[28:31], v[48:51]
    s_lshl_b64 s[52:53], s[58:59], 0
    v_cndmask_b32 v56, v56, v52, s[52:53]
    v_cndmask_b32 v57, v57, v53, s[52:53]
    v_cndmask_b32 v58, v58, v54, s[52:53]
    v_cndmask_b32 v59, v59, v55, s[52:53]
    s_waitcnt lgkmcnt(0)
    ds_read_b128 v[32:35], v6 offset:8192
    ds_read_b128 v[36:39], v7 offset:8192
    ds_read_b128 v[40:43], v8 offset:8192
    ds_read_b128 v[44:47], v9 offset:8192
    v_mfma_f32_16x16x32_bf16 v[52:55], v[88:91], v[16:19], 0
    v_mfma_f32_16x16x32_bf16 v[52:55], v[92:95], v[20:23], v[52:55]
    v_mfma_f32_16x16x32_bf16 v[52:55], v[96:99], v[24:27], v[52:55]
    v_mfma_f32_16x16x32_bf16 v[52:55], v[100:103], v[28:31], v[52:55]
    s_lshl_b64 s[52:53], s[58:59], 9
    v_cndmask_b32 v56, v56, v48, s[52:53]
    v_cndmask_b32 v57, v57, v49, s[52:53]
    v_cndmask_b32 v58, v58, v50, s[52:53]
    v_cndmask_b32 v59, v59, v51, s[52:53]
    s_waitcnt lgkmcnt(0)
    v_mfma_f32_16x16x32_bf16 v[48:51], v[32:35], v[16:19], 0
    v_mfma_f32_16x16x32_bf16 v[48:51], v[36:39], v[20:23], v[48:51]
    v_mfma_f32_16x16x32_bf16 v[48:51], v[40:43], v[24:27], v[48:51]
    v_mfma_f32_16x16x32_bf16 v[48:51], v[44:47], v[28:31], v[48:51]
    s_lshl_b64 s[52:53], s[58:59], 1
    v_cndmask_b32 v56, v56, v52, s[52:53]
    v_cndmask_b32 v57, v57, v53, s[52:53]
    v_cndmask_b32 v58, v58, v54, s[52:53]
    v_cndmask_b32 v59, v59, v55, s[52:53]
    s_waitcnt lgkmcnt(0)
    ds_read_b128 v[32:35], v6 offset:12288
    ds_read_b128 v[36:39], v7 offset:12288
    ds_read_b128 v[40:43], v8 offset:12288
    ds_read_b128 v[44:47], v9 offset:12288
    v_mfma_f32_16x16x32_bf16 v[52:55], v[104:107], v[16:19], 0
    v_mfma_f32_16x16x32_bf16 v[52:55], v[108:111], v[20:23], v[52:55]
    v_mfma_f32_16x16x32_bf16 v[52:55], v[112:115], v[24:27], v[52:55]
    v_mfma_f32_16x16x32_bf16 v[52:55], v[116:119], v[28:31], v[52:55]
    s_lshl_b64 s[52:53], s[58:59], 10
    v_cndmask_b32 v56, v56, v48, s[52:53]
    v_cndmask_b32 v57, v57, v49, s[52:53]
    v_cndmask_b32 v58, v58, v50, s[52:53]
    v_cndmask_b32 v59, v59, v51, s[52:53]
    s_waitcnt lgkmcnt(0)
    v_mfma_f32_16x16x32_bf16 v[48:51], v[32:35], v[16:19], 0
    v_mfma_f32_16x16x32_bf16 v[48:51], v[36:39], v[20:23], v[48:51]
    v_mfma_f32_16x16x32_bf16 v[48:51], v[40:43], v[24:27], v[48:51]
    v_mfma_f32_16x16x32_bf16 v[48:51], v[44:47], v[28:31], v[48:51]
    s_lshl_b64 s[52:53], s[58:59], 2
    v_cndmask_b32 v56, v56, v52, s[52:53]
    v_cndmask_b32 v57, v57, v53, s[52:53]
    v_cndmask_b32 v58, v58, v54, s[52:53]
    v_cndmask_b32 v59, v59, v55, s[52:53]
    s_waitcnt lgkmcnt(0)
    ds_read_b128 v[32:35], v6 offset:16384
    ds_read_b128 v[36:39], v7 offset:16384
    ds_read_b128 v[40:43], v8 offset:16384
    ds_read_b128 v[44:47], v9 offset:16384
    v_mfma_f32_16x16x32_bf16 v[52:55], v[120:123], v[16:19], 0
    v_mfma_f32_16x16x32_bf16 v[52:55], v[124:127], v[20:23], v[52:55]
    v_mfma_f32_16x16x32_bf16 v[52:55], v[128:131], v[24:27], v[52:55]
    v_mfma_f32_16x16x32_bf16 v[52:55], v[132:135], v[28:31], v[52:55]
    s_lshl_b64 s[52:53], s[58:59], 11
    v_cndmask_b32 v56, v56, v48, s[52:53]
    v_cndmask_b32 v57, v57, v49, s[52:53]
    v_cndmask_b32 v58, v58, v50, s[52:53]
    v_cndmask_b32 v59, v59, v51, s[52:53]
    s_waitcnt lgkmcnt(0)
    v_mfma_f32_16x16x32_bf16 v[48:51], v[32:35], v[16:19], 0
    v_mfma_f32_16x16x32_bf16 v[48:51], v[36:39], v[20:23], v[48:51]
    v_mfma_f32_16x16x32_bf16 v[48:51], v[40:43], v[24:27], v[48:51]
    v_mfma_f32_16x16x32_bf16 v[48:51], v[44:47], v[28:31], v[48:51]
    s_lshl_b64 s[52:53], s[58:59], 3
    v_cndmask_b32 v56, v56, v52, s[52:53]
    v_cndmask_b32 v57, v57, v53, s[52:53]
    v_cndmask_b32 v58, v58, v54, s[52:53]
    v_cndmask_b32 v59, v59, v55, s[52:53]
    s_waitcnt lgkmcnt(0)
    ds_read_b128 v[32:35], v6 offset:20480
    ds_read_b128 v[36:39], v7 offset:20480
    ds_read_b128 v[40:43], v8 offset:20480
    ds_read_b128 v[44:47], v9 offset:20480
    v_mfma_f32_16x16x32_bf16 v[52:55], v[136:139], v[16:19], 0
    v_mfma_f32_16x16x32_bf16 v[52:55], v[140:143], v[20:23], v[52:55]
    v_mfma_f32_16x16x32_bf16 v[52:55], v[144:147], v[24:27], v[52:55]
    v_mfma_f32_16x16x32_bf16 v[52:55], v[148:151], v[28:31], v[52:55]
    s_lshl_b64 s[52:53], s[58:59], 12
    v_cndmask_b32 v56, v56, v48, s[52:53]
    v_cndmask_b32 v57, v57, v49, s[52:53]
    v_cndmask_b32 v58, v58, v50, s[52:53]
    v_cndmask_b32 v59, v59, v51, s[52:53]
    s_waitcnt lgkmcnt(0)
    v_mfma_f32_16x16x32_bf16 v[48:51], v[32:35], v[16:19], 0
    v_mfma_f32_16x16x32_bf16 v[48:51], v[36:39], v[20:23], v[48:51]
    v_mfma_f32_16x16x32_bf16 v[48:51], v[40:43], v[24:27], v[48:51]
    v_mfma_f32_16x16x32_bf16 v[48:51], v[44:47], v[28:31], v[48:51]
    s_lshl_b64 s[52:53], s[58:59], 4
    v_cndmask_b32 v56, v56, v52, s[52:53]
    v_cndmask_b32 v57, v57, v53, s[52:53]
    v_cndmask_b32 v58, v58, v54, s[52:53]
    v_cndmask_b32 v59, v59, v55, s[52:53]
    s_waitcnt lgkmcnt(0)
    ds_read_b128 v[32:35], v6 offset:24576
    ds_read_b128 v[36:39], v7 offset:24576
    ds_read_b128 v[40:43], v8 offset:24576
    ds_read_b128 v[44:47], v9 offset:24576
    v_mfma_f32_16x16x32_bf16 v[52:55], v[152:155], v[16:19], 0
    v_mfma_f32_16x16x32_bf16 v[52:55], v[156:159], v[20:23], v[52:55]
    v_mfma_f32_16x16x32_bf16 v[52:55], v[160:163], v[24:27], v[52:55]
    v_mfma_f32_16x16x32_bf16 v[52:55], v[164:167], v[28:31], v[52:55]
    s_lshl_b64 s[52:53], s[58:59], 13
    v_cndmask_b32 v56, v56, v48, s[52:53]
    v_cndmask_b32 v57, v57, v49, s[52:53]
    v_cndmask_b32 v58, v58, v50, s[52:53]
    v_cndmask_b32 v59, v59, v51, s[52:53]
    s_waitcnt lgkmcnt(0)
    v_mfma_f32_16x16x32_bf16 v[48:51], v[32:35], v[16:19], 0
    v_mfma_f32_16x16x32_bf16 v[48:51], v[36:39], v[20:23], v[48:51]
    v_mfma_f32_16x16x32_bf16 v[48:51], v[40:43], v[24:27], v[48:51]
    v_mfma_f32_16x16x32_bf16 v[48:51], v[44:47], v[28:31], v[48:51]
    s_lshl_b64 s[52:53], s[58:59], 5
    v_cndmask_b32 v56, v56, v52, s[52:53]
    v_cndmask_b32 v57, v57, v53, s[52:53]
    v_cndmask_b32 v58, v58, v54, s[52:53]
    v_cndmask_b32 v59, v59, v55, s[52:53]
    s_waitcnt lgkmcnt(0)
    ds_read_b128 v[32:35], v6 offset:28672
    ds_read_b128 v[36:39], v7 offset:28672
    ds_read_b128 v[40:43], v8 offset:28672
    ds_read_b128 v[44:47], v9 offset:28672
    v_mfma_f32_16x16x32_bf16 v[52:55], v[168:171], v[16:19], 0
    v_mfma_f32_16x16x32_bf16 v[52:55], v[172:175], v[20:23], v[52:55]
    v_mfma_f32_16x16x32_bf16 v[52:55], v[176:179], v[24:27], v[52:55]
    v_mfma_f32_16x16x32_bf16 v[52:55], v[180:183], v[28:31], v[52:55]
    s_lshl_b64 s[52:53], s[58:59], 14
    v_cndmask_b32 v56, v56, v48, s[52:53]
    v_cndmask_b32 v57, v57, v49, s[52:53]
    v_cndmask_b32 v58, v58, v50, s[52:53]
    v_cndmask_b32 v59, v59, v51, s[52:53]
    s_waitcnt lgkmcnt(0)
    v_mfma_f32_16x16x32_bf16 v[48:51], v[32:35], v[16:19], 0
    v_mfma_f32_16x16x32_bf16 v[48:51], v[36:39], v[20:23], v[48:51]
    v_mfma_f32_16x16x32_bf16 v[48:51], v[40:43], v[24:27], v[48:51]
    v_mfma_f32_16x16x32_bf16 v[48:51], v[44:47], v[28:31], v[48:51]
    s_lshl_b64 s[52:53], s[58:59], 6
    v_cndmask_b32 v56, v56, v52, s[52:53]
    v_cndmask_b32 v57, v57, v53, s[52:53]
    v_cndmask_b32 v58, v58, v54, s[52:53]
    v_cndmask_b32 v59, v59, v55, s[52:53]
    s_waitcnt lgkmcnt(0)
    v_mfma_f32_16x16x32_bf16 v[52:55], v[184:187], v[16:19], 0
    v_mfma_f32_16x16x32_bf16 v[52:55], v[188:191], v[20:23], v[52:55]
    v_mfma_f32_16x16x32_bf16 v[52:55], v[192:195], v[24:27], v[52:55]
    v_mfma_f32_16x16x32_bf16 v[52:55], v[196:199], v[28:31], v[52:55]
    s_lshl_b64 s[52:53], s[58:59], 15
    v_cndmask_b32 v56, v56, v48, s[52:53]
    v_cndmask_b32 v57, v57, v49, s[52:53]
    v_cndmask_b32 v58, v58, v50, s[52:53]
    v_cndmask_b32 v59, v59, v51, s[52:53]
    s_lshl_b64 s[52:53], s[58:59], 7
s_nop 1
    v_cndmask_b32 v56, v56, v52, s[52:53]
    v_cndmask_b32 v57, v57, v53, s[52:53]
    v_cndmask_b32 v58, v58, v54, s[52:53]
    v_cndmask_b32 v59, v59, v55, s[52:53]
    v_max3_f32 v70, v56, v57, v58
    v_max_f32 v70, v70, v59
s_nop 1
    v_max_f32_dpp v70, v70, v70 row_ror:8 row_mask:0xf bank_mask:0xf
s_nop 1
    v_max_f32_dpp v70, v70, v70 row_ror:4 row_mask:0xf bank_mask:0xf
s_nop 1
    v_max_f32_dpp v70, v70, v70 row_ror:2 row_mask:0xf bank_mask:0xf
s_nop 1
    v_max_f32_dpp v70, v70, v70 row_ror:1 row_mask:0xf bank_mask:0xf
    v_mov_b32 v71, v70
s_nop 1
    v_permlane16_swap_b32 v71, v70
    v_max_f32 v70, v71, v70
    v_mov_b32 v71, v70
s_nop 1
    v_permlane32_swap_b32 v71, v70
    v_max_f32 v70, v71, v70
    v_mov_b32 v68, v70
    v_mul_f32 v70, s60, v68
    v_fma_f32 v56, v56, s60, -v70
    v_fma_f32 v57, v57, s60, -v70
    v_fma_f32 v58, v58, s60, -v70
    v_fma_f32 v59, v59, s60, -v70
    v_exp_f32 v56, v56
    v_exp_f32 v57, v57
    v_exp_f32 v58, v58
    v_exp_f32 v59, v59
    v_cvt_pk_bf16_f32 v48, v56, v56
    v_cvt_pk_bf16_f32 v49, v57, v57
    v_cvt_pk_bf16_f32 v50, v58, v58
    v_cvt_pk_bf16_f32 v51, v59, v59
    ds_write_b32 v14, v48 offset:0
    ds_write_b32 v14, v49 offset:144
    ds_write_b32 v14, v50 offset:288
    ds_write_b32 v14, v51 offset:432
    v_add_f32 v56, v56, v57
    v_add_f32 v58, v58, v59
    v_add_f32 v56, v56, v58
    v_mov_b32 v69, v56
    s_waitcnt lgkmcnt(0)
    ds_read_b128 v[40:43], v15 offset:0
    s_waitcnt lgkmcnt(0)
    ds_read_b128 v[44:47], v15 offset:16
    v_and_b32 v32, v40, v10
    v_and_b32 v33, v40, v11
    v_and_b32 v34, v40, v12
    v_and_b32 v35, v40, v13
    s_waitcnt vmcnt(0)
    v_lshrrev_b32 v70, 4, v0
    v_lshlrev_b32 v70, 3, v70
    v_bfe_u32 v71, v0, 2, 2
    v_add_u32 v70, v70, v71
    v_lshlrev_b32 v70, 5, v70
    v_and_b32 v71, 3, v0
    v_lshl_add_u32 v70, v71, 3, v70
    v_add_u32 v70, s44, v70
    ds_read_b64_tr_b16 v[16:17], v70 offset:0
    ds_read_b64_tr_b16 v[18:19], v70 offset:128
    ds_read_b64_tr_b16 v[20:21], v70 offset:1024
    ds_read_b64_tr_b16 v[22:23], v70 offset:1152
    ds_read_b64_tr_b16 v[24:25], v70 offset:2048
    ds_read_b64_tr_b16 v[26:27], v70 offset:2176
    ds_read_b64_tr_b16 v[28:29], v70 offset:3072
    ds_read_b64_tr_b16 v[30:31], v70 offset:3200
    v_add_f32_dpp v69, v69, v69 row_ror:8 row_mask:0xf bank_mask:0xf
s_nop 1
    v_add_f32_dpp v69, v69, v69 row_ror:4 row_mask:0xf bank_mask:0xf
s_nop 1
    v_add_f32_dpp v69, v69, v69 row_ror:2 row_mask:0xf bank_mask:0xf
s_nop 1
    v_add_f32_dpp v69, v69, v69 row_ror:1 row_mask:0xf bank_mask:0xf
    v_mov_b32 v70, v69
s_nop 1
    v_permlane16_swap_b32 v70, v69
    v_add_f32 v69, v70, v69
    v_mov_b32 v70, v69
s_nop 1
    v_permlane32_swap_b32 v70, v69
    v_add_f32 v69, v70, v69
    s_lshl_b32 s54, s38, 3
    s_add_u32 s54, s54, 156160
    v_mov_b32 v70, s54
    ds_write_b64 v70, v[68:69]
    s_waitcnt lgkmcnt(0)
    s_cmp_lt_u32 s2, 112
    s_cbranch_scc1 Ls2_24
    s_mov_b32 s16, s20
    s_and_b32 s17, s21, 0xffff
    s_mov_b32 s18, 4194304
    s_mov_b32 s19, 0x20000
    s_mov_b32 s55, 8192
    s_lshr_b32 s56, s40, 1
    s_lshl_b32 s56, s56, 20
    s_lshl_b32 s57, s39, 8
    s_add_u32 s56, s56, s57
    s_and_b32 s57, s40, 1
    s_lshl_b32 s57, s57, 7
    s_add_u32 s56, s56, s57
    s_lshl_b32 s57, s38, 5
    s_add_u32 s56, s56, s57
    s_branch Ls2j_25
Ls2_24:
    s_mov_b32 s16, s24
    s_and_b32 s17, s25, 0xffff
    s_mov_b32 s18, 1835008
    s_mov_b32 s19, 0x20000
    s_mov_b32 s55, 3584
    s_mul_i32 s56, s38, 458752
    s_lshl_b32 s57, s2, 5
    s_add_u32 s56, s56, s57
Ls2j_25:
    v_lshrrev_b32 v70, 1, v0
    v_mul_lo_u32 v70, v70, s55
    v_and_b32 v71, 1, v0
    v_lshl_add_u32 v70, v71, 4, v70
    s_lshl_b32 s57, s55, 5
    s_add_u32 m0, s44, 0
s_nop 0
    buffer_load_dwordx4 v70, s[16:19], s56 offen lds
    s_add_u32 m0, s44, 1024
    s_add_u32 s56, s56, s57
    buffer_load_dwordx4 v70, s[16:19], s56 offen lds
    s_add_u32 m0, s44, 2048
    s_add_u32 s56, s56, s57
    buffer_load_dwordx4 v70, s[16:19], s56 offen lds
    s_add_u32 m0, s44, 3072
    s_add_u32 s56, s56, s57
    buffer_load_dwordx4 v70, s[16:19], s56 offen lds
    v_and_b32 v36, v41, v10
    v_and_b32 v37, v41, v11
    v_mfma_f32_16x16x32_bf16 v[60:63], a[0:3], v[32:35], 0
    v_and_b32 v38, v41, v12
    v_and_b32 v39, v41, v13
    v_mfma_f32_16x16x32_bf16 v[64:67], a[4:7], v[32:35], 0
    v_and_b32 v32, v42, v10
    v_and_b32 v33, v42, v11
    v_mfma_f32_16x16x32_bf16 v[60:63], a[8:11], v[36:39], v[60:63]
    v_and_b32 v34, v42, v12
    v_and_b32 v35, v42, v13
    v_mfma_f32_16x16x32_bf16 v[64:67], a[12:15], v[36:39], v[64:67]
    v_and_b32 v36, v43, v10
    v_and_b32 v37, v43, v11
    v_mfma_f32_16x16x32_bf16 v[60:63], a[16:19], v[32:35], v[60:63]
    v_and_b32 v38, v43, v12
    v_and_b32 v39, v43, v13
    v_mfma_f32_16x16x32_bf16 v[64:67], a[20:23], v[32:35], v[64:67]
    s_waitcnt lgkmcnt(9)
    v_and_b32 v32, v44, v10
    v_and_b32 v33, v44, v11
    v_mfma_f32_16x16x32_bf16 v[60:63], a[24:27], v[36:39], v[60:63]
    v_and_b32 v34, v44, v12
    v_and_b32 v35, v44, v13
    v_mfma_f32_16x16x32_bf16 v[64:67], a[28:31], v[36:39], v[64:67]
    ds_read_b128 v[40:43], v15 offset:32
    v_and_b32 v36, v45, v10
    v_and_b32 v37, v45, v11
    v_mfma_f32_16x16x32_bf16 v[60:63], a[32:35], v[32:35], v[60:63]
    v_and_b32 v38, v45, v12
    v_and_b32 v39, v45, v13
    v_mfma_f32_16x16x32_bf16 v[64:67], a[36:39], v[32:35], v[64:67]
    v_and_b32 v32, v46, v10
    v_and_b32 v33, v46, v11
    v_mfma_f32_16x16x32_bf16 v[60:63], a[40:43], v[36:39], v[60:63]
    v_and_b32 v34, v46, v12
    v_and_b32 v35, v46, v13
    v_mfma_f32_16x16x32_bf16 v[64:67], a[44:47], v[36:39], v[64:67]
    v_and_b32 v36, v47, v10
    v_and_b32 v37, v47, v11
    v_mfma_f32_16x16x32_bf16 v[60:63], a[48:51], v[32:35], v[60:63]
    v_and_b32 v38, v47, v12
    v_and_b32 v39, v47, v13
    v_mfma_f32_16x16x32_bf16 v[64:67], a[52:55], v[32:35], v[64:67]
    s_waitcnt lgkmcnt(0)
    v_and_b32 v32, v40, v10
    v_and_b32 v33, v40, v11
    v_mfma_f32_16x16x32_bf16 v[60:63], a[56:59], v[36:39], v[60:63]
    v_and_b32 v34, v40, v12
    v_and_b32 v35, v40, v13
    v_mfma_f32_16x16x32_bf16 v[64:67], a[60:63], v[36:39], v[64:67]
    ds_read_b128 v[44:47], v15 offset:48
    v_and_b32 v36, v41, v10
    v_and_b32 v37, v41, v11
    v_mfma_f32_16x16x32_bf16 v[60:63], a[64:67], v[32:35], v[60:63]
    v_and_b32 v38, v41, v12
    v_and_b32 v39, v41, v13
    v_mfma_f32_16x16x32_bf16 v[64:67], a[68:71], v[32:35], v[64:67]
    v_and_b32 v32, v42, v10
    v_and_b32 v33, v42, v11
    v_mfma_f32_16x16x32_bf16 v[60:63], a[72:75], v[36:39], v[60:63]
    v_and_b32 v34, v42, v12
    v_and_b32 v35, v42, v13
    v_mfma_f32_16x16x32_bf16 v[64:67], a[76:79], v[36:39], v[64:67]
    v_and_b32 v36, v43, v10
    v_and_b32 v37, v43, v11
    v_mfma_f32_16x16x32_bf16 v[60:63], a[80:83], v[32:35], v[60:63]
    v_and_b32 v38, v43, v12
    v_and_b32 v39, v43, v13
    v_mfma_f32_16x16x32_bf16 v[64:67], a[84:87], v[32:35], v[64:67]
    s_waitcnt lgkmcnt(0)
    v_and_b32 v32, v44, v10
    v_and_b32 v33, v44, v11
    v_mfma_f32_16x16x32_bf16 v[60:63], a[88:91], v[36:39], v[60:63]
    v_and_b32 v34, v44, v12
    v_and_b32 v35, v44, v13
    v_mfma_f32_16x16x32_bf16 v[64:67], a[92:95], v[36:39], v[64:67]
    ds_read_b128 v[40:43], v15 offset:64
    v_and_b32 v36, v45, v10
    v_and_b32 v37, v45, v11
    v_mfma_f32_16x16x32_bf16 v[60:63], a[96:99], v[32:35], v[60:63]
    v_and_b32 v38, v45, v12
    v_and_b32 v39, v45, v13
    v_mfma_f32_16x16x32_bf16 v[64:67], a[100:103], v[32:35], v[64:67]
    v_and_b32 v32, v46, v10
    v_and_b32 v33, v46, v11
    v_mfma_f32_16x16x32_bf16 v[60:63], a[104:107], v[36:39], v[60:63]
    v_and_b32 v34, v46, v12
    v_and_b32 v35, v46, v13
    v_mfma_f32_16x16x32_bf16 v[64:67], a[108:111], v[36:39], v[64:67]
    v_and_b32 v36, v47, v10
    v_and_b32 v37, v47, v11
    v_mfma_f32_16x16x32_bf16 v[60:63], a[112:115], v[32:35], v[60:63]
    v_and_b32 v38, v47, v12
    v_and_b32 v39, v47, v13
    v_mfma_f32_16x16x32_bf16 v[64:67], a[116:119], v[32:35], v[64:67]
    s_waitcnt lgkmcnt(0)
    v_and_b32 v32, v40, v10
    v_and_b32 v33, v40, v11
    v_mfma_f32_16x16x32_bf16 v[60:63], a[120:123], v[36:39], v[60:63]
    v_and_b32 v34, v40, v12
    v_and_b32 v35, v40, v13
    v_mfma_f32_16x16x32_bf16 v[64:67], a[124:127], v[36:39], v[64:67]
    ds_read_b128 v[44:47], v15 offset:80
    v_and_b32 v36, v41, v10
    v_and_b32 v37, v41, v11
    v_mfma_f32_16x16x32_bf16 v[60:63], a[128:131], v[32:35], v[60:63]
    v_and_b32 v38, v41, v12
    v_and_b32 v39, v41, v13
    v_mfma_f32_16x16x32_bf16 v[64:67], a[132:135], v[32:35], v[64:67]
    v_and_b32 v32, v42, v10
    v_and_b32 v33, v42, v11
    v_mfma_f32_16x16x32_bf16 v[60:63], a[136:139], v[36:39], v[60:63]
    v_and_b32 v34, v42, v12
    v_and_b32 v35, v42, v13
    v_mfma_f32_16x16x32_bf16 v[64:67], a[140:143], v[36:39], v[64:67]
    v_and_b32 v36, v43, v10
    v_and_b32 v37, v43, v11
    v_mfma_f32_16x16x32_bf16 v[60:63], a[144:147], v[32:35], v[60:63]
    v_and_b32 v38, v43, v12
    v_and_b32 v39, v43, v13
    v_mfma_f32_16x16x32_bf16 v[64:67], a[148:151], v[32:35], v[64:67]
    s_waitcnt lgkmcnt(0)
    v_and_b32 v32, v44, v10
    v_and_b32 v33, v44, v11
    v_mfma_f32_16x16x32_bf16 v[60:63], a[152:155], v[36:39], v[60:63]
    v_and_b32 v34, v44, v12
    v_and_b32 v35, v44, v13
    v_mfma_f32_16x16x32_bf16 v[64:67], a[156:159], v[36:39], v[64:67]
    ds_read_b128 v[40:43], v15 offset:96
    v_and_b32 v36, v45, v10
    v_and_b32 v37, v45, v11
    v_mfma_f32_16x16x32_bf16 v[60:63], a[160:163], v[32:35], v[60:63]
    v_and_b32 v38, v45, v12
    v_and_b32 v39, v45, v13
    v_mfma_f32_16x16x32_bf16 v[64:67], a[164:167], v[32:35], v[64:67]
    v_and_b32 v32, v46, v10
    v_and_b32 v33, v46, v11
    v_mfma_f32_16x16x32_bf16 v[60:63], a[168:171], v[36:39], v[60:63]
    v_and_b32 v34, v46, v12
    v_and_b32 v35, v46, v13
    v_mfma_f32_16x16x32_bf16 v[64:67], a[172:175], v[36:39], v[64:67]
    v_and_b32 v36, v47, v10
    v_and_b32 v37, v47, v11
    v_mfma_f32_16x16x32_bf16 v[60:63], a[176:179], v[32:35], v[60:63]
    v_and_b32 v38, v47, v12
    v_and_b32 v39, v47, v13
    v_mfma_f32_16x16x32_bf16 v[64:67], a[180:183], v[32:35], v[64:67]
    s_waitcnt lgkmcnt(0)
    v_and_b32 v32, v40, v10
    v_and_b32 v33, v40, v11
    v_mfma_f32_16x16x32_bf16 v[60:63], a[184:187], v[36:39], v[60:63]
    v_and_b32 v34, v40, v12
    v_and_b32 v35, v40, v13
    v_mfma_f32_16x16x32_bf16 v[64:67], a[188:191], v[36:39], v[64:67]
    ds_read_b128 v[44:47], v15 offset:112
    v_and_b32 v36, v41, v10
    v_and_b32 v37, v41, v11
    v_mfma_f32_16x16x32_bf16 v[60:63], a[192:195], v[32:35], v[60:63]
    v_and_b32 v38, v41, v12
    v_and_b32 v39, v41, v13
    v_mfma_f32_16x16x32_bf16 v[64:67], a[196:199], v[32:35], v[64:67]
    v_and_b32 v32, v42, v10
    v_and_b32 v33, v42, v11
    v_mfma_f32_16x16x32_bf16 v[60:63], a[200:203], v[36:39], v[60:63]
    v_and_b32 v34, v42, v12
    v_and_b32 v35, v42, v13
    v_mfma_f32_16x16x32_bf16 v[64:67], a[204:207], v[36:39], v[64:67]
    v_and_b32 v36, v43, v10
    v_and_b32 v37, v43, v11
    v_mfma_f32_16x16x32_bf16 v[60:63], a[208:211], v[32:35], v[60:63]
    v_and_b32 v38, v43, v12
    v_and_b32 v39, v43, v13
    v_mfma_f32_16x16x32_bf16 v[64:67], a[212:215], v[32:35], v[64:67]
    s_waitcnt lgkmcnt(0)
    v_and_b32 v32, v44, v10
    v_and_b32 v33, v44, v11
    v_mfma_f32_16x16x32_bf16 v[60:63], a[216:219], v[36:39], v[60:63]
    v_and_b32 v34, v44, v12
    v_and_b32 v35, v44, v13
    v_mfma_f32_16x16x32_bf16 v[64:67], a[220:223], v[36:39], v[64:67]
    v_and_b32 v36, v45, v10
    v_and_b32 v37, v45, v11
    v_mfma_f32_16x16x32_bf16 v[60:63], a[224:227], v[32:35], v[60:63]
    v_and_b32 v38, v45, v12
    v_and_b32 v39, v45, v13
    v_mfma_f32_16x16x32_bf16 v[64:67], a[228:231], v[32:35], v[64:67]
    v_and_b32 v32, v46, v10
    v_and_b32 v33, v46, v11
    v_mfma_f32_16x16x32_bf16 v[60:63], a[232:235], v[36:39], v[60:63]
    v_and_b32 v34, v46, v12
    v_and_b32 v35, v46, v13
    v_mfma_f32_16x16x32_bf16 v[64:67], a[236:239], v[36:39], v[64:67]
    v_and_b32 v36, v47, v10
    v_and_b32 v37, v47, v11
    v_mfma_f32_16x16x32_bf16 v[60:63], a[240:243], v[32:35], v[60:63]
    v_and_b32 v38, v47, v12
    v_and_b32 v39, v47, v13
    v_mfma_f32_16x16x32_bf16 v[64:67], a[244:247], v[32:35], v[64:67]
s_nop 0
    v_mfma_f32_16x16x32_bf16 v[60:63], a[248:251], v[36:39], v[60:63]
    v_mfma_f32_16x16x32_bf16 v[64:67], a[252:255], v[36:39], v[64:67]
L_TAIL:
    v_and_b32 v70, 15, v0
    v_lshrrev_b32 v71, 3, v70
    s_lshl_b32 s54, s38, 1
    v_add_u32 v71, s54, v71
    v_lshlrev_b32 v71, 9, v71
    v_and_b32 v70, 7, v70
    v_lshl_add_u32 v71, v70, 2, v71
    v_lshrrev_b32 v70, 4, v0
    v_lshl_add_u32 v71, v70, 7, v71
    v_add_u32 v71, 152064, v71
    v_cndmask_b32 v48, v64, v60, s[62:63]
    v_cndmask_b32 v49, v65, v61, s[62:63]
    v_cndmask_b32 v50, v66, v62, s[62:63]
    v_cndmask_b32 v51, v67, v63, s[62:63]
    ds_write_b32 v71, v48 offset:0
    ds_write_b32 v71, v49 offset:32
    ds_write_b32 v71, v50 offset:64
    ds_write_b32 v71, v51 offset:96
    s_and_b32 s54, s38, 1
    s_lshl_b32 s54, s54, 8
    v_lshlrev_b32 v32, 2, v0
    v_add_u32 v32, s54, v32
    v_add_u32 v70, 152064, v32
    v_mov_b32 v71, 156160
    s_waitcnt lgkmcnt(0)
    s_barrier
    ds_read_b32 v48, v70 offset:0
    ds_read_b32 v49, v70 offset:512
    ds_read_b32 v50, v70 offset:1024
    ds_read_b32 v51, v70 offset:1536
    ds_read_b32 v52, v70 offset:2048
    ds_read_b32 v53, v70 offset:2560
    ds_read_b32 v54, v70 offset:3072
    ds_read_b32 v55, v70 offset:3584
    ds_read_b128 v[56:59], v71
    ds_read_b128 v[60:63], v71 offset:16
    ds_read_b32 v66, v71 offset:4624
    s_add_u32 s54, s61, s46
    s_min_u32 s56, s99, 1
    s_lshl_b32 s55, s56, 3
    s_add_u32 s55, s55, s54
    s_lshl_b32 s56, s56, 9
    s_add_u32 s54, s54, s56
    s_waitcnt lgkmcnt(0)
    v_readfirstlane_b32 s47, v66
    v_max3_f32 v64, v56, v58, v60
    v_max_f32 v64, v64, v62
    v_sub_f32 v56, v56, v64
    v_sub_f32 v58, v58, v64
    v_sub_f32 v60, v60, v64
    v_sub_f32 v62, v62, v64
    v_mul_f32 v56, s60, v56
    v_mul_f32 v58, s60, v58
    v_mul_f32 v60, s60, v60
    v_mul_f32 v62, s60, v62
    v_exp_f32 v56, v56
    v_exp_f32 v58, v58
    v_exp_f32 v60, v60
    v_exp_f32 v62, v62
    v_add_f32 v48, v48, v49
    v_add_f32 v50, v50, v51
    v_add_f32 v52, v52, v53
    v_add_f32 v54, v54, v55
    v_mul_f32 v48, v56, v48
    v_mul_f32 v65, v56, v57
    v_fmac_f32 v48, v58, v50
    v_fmac_f32 v65, v58, v59
    v_fmac_f32 v48, v60, v52
    v_fmac_f32 v65, v60, v61
    v_fmac_f32 v48, v62, v54
    v_fmac_f32 v65, v62, v63
    s_cmp_ge_u32 s38, 2
    s_cbranch_scc1 Lop_26
    s_cmp_eq_u32 s47, 0
    s_cbranch_scc1 Lsg_27
    buffer_store_dword v48, v32, s[12:15], s54 offen offset:1024
    s_branch Lsj_28
Lsg_27:
    buffer_store_dword v48, v32, s[12:15], s54 offen offset:1024 sc1
Lsj_28:
    s_cmp_lg_u32 s38, 0
    s_cbranch_scc1 Lop_26
    s_mov_b64 s[50:51], exec
    s_mov_b64 exec, 1
    s_cmp_eq_u32 s47, 0
    s_cbranch_scc1 Lsg_29
    buffer_store_dwordx2 v[64:65], off, s[12:15], s55 offset:784
    s_branch Lsj_30
Lsg_29:
    buffer_store_dwordx2 v[64:65], off, s[12:15], s55 offset:784 sc1
Lsj_30:
    s_mov_b64 exec, s[50:51]
Lop_26:
    s_waitcnt vmcnt(0)
    v_lshrrev_b32 v70, 4, v0
    v_lshlrev_b32 v70, 3, v70
    v_bfe_u32 v71, v0, 2, 2
    v_add_u32 v70, v70, v71
    v_lshlrev_b32 v70, 5, v70
    v_and_b32 v71, 3, v0
    v_lshl_add_u32 v70, v71, 3, v70
    v_add_u32 v70, s44, v70
    ds_read_b64_tr_b16 v[32:33], v70 offset:0
    ds_read_b64_tr_b16 v[34:35], v70 offset:128
    ds_read_b64_tr_b16 v[36:37], v70 offset:1024
    ds_read_b64_tr_b16 v[38:39], v70 offset:1152
    ds_read_b64_tr_b16 v[40:41], v70 offset:2048
    ds_read_b64_tr_b16 v[42:43], v70 offset:2176
    ds_read_b64_tr_b16 v[44:45], v70 offset:3072
    ds_read_b64_tr_b16 v[46:47], v70 offset:3200
    s_cmp_lt_u32 s2, 112
    s_cbranch_scc0 Lnf_31
    v_mov_b32 v48, 0x3f803f80
    v_mov_b32 v49, v48
    v_mov_b32 v50, v48
    v_mov_b32 v51, v48
    s_waitcnt lgkmcnt(0)
s_nop 0
    v_mfma_f32_16x16x32_bf16 v[60:63], v[32:35], v[48:51], 0
    v_mfma_f32_16x16x32_bf16 v[60:63], v[36:39], v[48:51], v[60:63]
    v_mfma_f32_16x16x32_bf16 v[60:63], v[40:43], v[48:51], v[60:63]
    v_mfma_f32_16x16x32_bf16 v[60:63], v[44:47], v[48:51], v[60:63]
    s_lshl_b32 s54, s38, 6
    s_add_u32 s54, s54, 160512
    v_and_b32 v70, 48, v0
    v_add_u32 v70, s54, v70
s_nop 3
    ds_write_b128 v70, v[60:63]
Lnf_31:
    s_waitcnt lgkmcnt(0)
    s_and_b32 s54, s39, 28
    s_add_u32 s54, s54, s38
    s_lshl_b32 s54, s54, 17
    s_add_u32 s54, s54, s46
    s_cmp_eq_u32 s99, 1
    s_cselect_b32 s55, 1, 0
    s_lshr_b32 s56, s99, 1
    v_lshrrev_b32 v70, 5, v0
    v_and_b32 v70, s55, v70
    v_add_u32 v70, s56, v70
    v_and_b32 v71, 7, v0
    v_lshlrev_b32 v71, 14, v71
    v_lshl_add_u32 v3, v70, 3, v71
    v_and_b32 v71, 31, v0
    v_lshlrev_b32 v71, 4, v71
    v_lshl_add_u32 v2, v70, 9, v71
    s_mov_b32 s48, 200000
Lpoll_32:
    buffer_load_dwordx4 v[200:203], v2, s[12:15], s54 offen offset:1024 sc1
    s_add_u32 s55, s54, 16384
    buffer_load_dwordx4 v[204:207], v2, s[12:15], s55 offen offset:1024 sc1
    s_add_u32 s55, s54, 32768
    buffer_load_dwordx4 v[208:211], v2, s[12:15], s55 offen offset:1024 sc1
    s_add_u32 s55, s54, 49152
    buffer_load_dwordx4 v[212:215], v2, s[12:15], s55 offen offset:1024 sc1
    s_add_u32 s55, s54, 65536
    buffer_load_dwordx4 v[216:219], v2, s[12:15], s55 offen offset:1024 sc1
    s_add_u32 s55, s54, 81920
    buffer_load_dwordx4 v[220:223], v2, s[12:15], s55 offen offset:1024 sc1
    s_add_u32 s55, s54, 98304
    buffer_load_dwordx4 v[224:227], v2, s[12:15], s55 offen offset:1024 sc1
    s_add_u32 s55, s54, 114688
    buffer_load_dwordx4 v[228:231], v2, s[12:15], s55 offen offset:1024 sc1
    buffer_load_dwordx2 v[64:65], v3, s[12:15], s54 offen offset:784 sc1
    s_waitcnt vmcnt(0)
    v_max3_u32 v70, v200, v201, v202
    v_max3_u32 v70, v70, v203, v204
    v_max3_u32 v70, v70, v205, v206
    v_max3_u32 v70, v70, v207, v208
    v_max3_u32 v70, v70, v209, v210
    v_max3_u32 v70, v70, v211, v212
    v_max3_u32 v70, v70, v213, v214
    v_max3_u32 v70, v70, v215, v216
    v_max3_u32 v70, v70, v217, v218
    v_max3_u32 v70, v70, v219, v220
    v_max3_u32 v70, v70, v221, v222
    v_max3_u32 v70, v70, v223, v224
    v_max3_u32 v70, v70, v225, v226
    v_max3_u32 v70, v70, v227, v228
    v_max3_u32 v70, v70, v229, v230
    v_max3_u32 v70, v70, v231, v64
    v_max_u32 v70, v70, v65
    v_cmp_eq_u32 vcc, -1, v70
    s_cbranch_vccz Lok_33
    s_sub_u32 s48, s48, 1
    s_cmp_lg_u32 s48, 0
    s_cbranch_scc1 Lpoll_32
Lok_33:
    v_max_f32_dpp v66, v64, v64 quad_perm:[1,0,3,2] row_mask:0xf bank_mask:0xf
    s_lshl_b32 s54, s38, 9
    s_add_u32 s54, s54, 157888
    v_max_f32_dpp v66, v66, v66 quad_perm:[2,3,0,1] row_mask:0xf bank_mask:0xf
s_nop 1
    v_max_f32_dpp v66, v66, v66 row_half_mirror row_mask:0xf bank_mask:0xf
    v_lshlrev_b32 v2, 3, v0
    v_add_u32 v2, s54, v2
    v_sub_f32 v66, v64, v66
    v_mul_f32 v66, s60, v66
    v_exp_f32 v66, v66
    v_and_b32 v70, 1, v0
    v_and_b32 v71, 48, v0
    v_mul_f32 v67, v66, v65
    v_lshl_add_u32 v3, v70, 8, v71
    v_add_u32 v3, s54, v3
    v_add_f32_dpp v67, v67, v67 quad_perm:[1,0,3,2] row_mask:0xf bank_mask:0xf
    v_lshlrev_b32 v71, 1, v71
    v_lshl_add_u32 v8, v70, 4, v71
    v_add_f32_dpp v67, v67, v67 quad_perm:[2,3,0,1] row_mask:0xf bank_mask:0xf
s_nop 1
    v_add_f32_dpp v67, v67, v67 row_half_mirror row_mask:0xf bank_mask:0xf
    v_add_u32 v8, 159936, v8
    v_rcp_f32 v67, v67
    s_lshl_b32 s55, s38, 7
    v_add_u32 v9, s55, v8
    v_mul_f32 v66, v66, v67
s_nop 1
    v_mul_f32_dpp v4, v66, v200 row_newbcast:0 row_mask:0xf bank_mask:0xf
    v_mul_f32_dpp v5, v66, v201 row_newbcast:0 row_mask:0xf bank_mask:0xf
    v_mul_f32_dpp v6, v66, v202 row_newbcast:0 row_mask:0xf bank_mask:0xf
    v_mul_f32_dpp v7, v66, v203 row_newbcast:0 row_mask:0xf bank_mask:0xf
    v_fmac_f32_dpp v4, v66, v204 row_newbcast:1 row_mask:0xf bank_mask:0xf
    v_fmac_f32_dpp v5, v66, v205 row_newbcast:1 row_mask:0xf bank_mask:0xf
    v_fmac_f32_dpp v6, v66, v206 row_newbcast:1 row_mask:0xf bank_mask:0xf
    v_fmac_f32_dpp v7, v66, v207 row_newbcast:1 row_mask:0xf bank_mask:0xf
    v_fmac_f32_dpp v4, v66, v208 row_newbcast:2 row_mask:0xf bank_mask:0xf
    v_fmac_f32_dpp v5, v66, v209 row_newbcast:2 row_mask:0xf bank_mask:0xf
    v_fmac_f32_dpp v6, v66, v210 row_newbcast:2 row_mask:0xf bank_mask:0xf
    v_fmac_f32_dpp v7, v66, v211 row_newbcast:2 row_mask:0xf bank_mask:0xf
    v_fmac_f32_dpp v4, v66, v212 row_newbcast:3 row_mask:0xf bank_mask:0xf
    v_fmac_f32_dpp v5, v66, v213 row_newbcast:3 row_mask:0xf bank_mask:0xf
    v_fmac_f32_dpp v6, v66, v214 row_newbcast:3 row_mask:0xf bank_mask:0xf
    v_fmac_f32_dpp v7, v66, v215 row_newbcast:3 row_mask:0xf bank_mask:0xf
    v_fmac_f32_dpp v4, v66, v216 row_newbcast:4 row_mask:0xf bank_mask:0xf
    v_fmac_f32_dpp v5, v66, v217 row_newbcast:4 row_mask:0xf bank_mask:0xf
    v_fmac_f32_dpp v6, v66, v218 row_newbcast:4 row_mask:0xf bank_mask:0xf
    v_fmac_f32_dpp v7, v66, v219 row_newbcast:4 row_mask:0xf bank_mask:0xf
    v_fmac_f32_dpp v4, v66, v220 row_newbcast:5 row_mask:0xf bank_mask:0xf
    v_fmac_f32_dpp v5, v66, v221 row_newbcast:5 row_mask:0xf bank_mask:0xf
    v_fmac_f32_dpp v6, v66, v222 row_newbcast:5 row_mask:0xf bank_mask:0xf
    v_fmac_f32_dpp v7, v66, v223 row_newbcast:5 row_mask:0xf bank_mask:0xf
    v_fmac_f32_dpp v4, v66, v224 row_newbcast:6 row_mask:0xf bank_mask:0xf
    v_fmac_f32_dpp v5, v66, v225 row_newbcast:6 row_mask:0xf bank_mask:0xf
    v_fmac_f32_dpp v6, v66, v226 row_newbcast:6 row_mask:0xf bank_mask:0xf
    v_fmac_f32_dpp v7, v66, v227 row_newbcast:6 row_mask:0xf bank_mask:0xf
    v_fmac_f32_dpp v4, v66, v228 row_newbcast:7 row_mask:0xf bank_mask:0xf
    v_fmac_f32_dpp v5, v66, v229 row_newbcast:7 row_mask:0xf bank_mask:0xf
    v_fmac_f32_dpp v6, v66, v230 row_newbcast:7 row_mask:0xf bank_mask:0xf
    v_fmac_f32_dpp v7, v66, v231 row_newbcast:7 row_mask:0xf bank_mask:0xf
    v_cvt_pk_bf16_f32 v4, v4, v5
    v_cvt_pk_bf16_f32 v5, v6, v7
    ds_write_b64 v2, v[4:5]
    ds_read_b128 v[48:51], v3 offset:0
    ds_read_b128 v[52:55], v3 offset:64
    ds_read_b128 v[56:59], v3 offset:128
    ds_read_b128 v[60:63], v3 offset:192
    s_waitcnt lgkmcnt(0)
    v_mfma_f32_16x16x32_bf16 v[64:67], v[16:19], v[48:51], 0
    v_mfma_f32_16x16x32_bf16 v[64:67], v[20:23], v[52:55], v[64:67]
    v_mfma_f32_16x16x32_bf16 v[64:67], v[24:27], v[56:59], v[64:67]
    v_mfma_f32_16x16x32_bf16 v[64:67], v[28:31], v[60:63], v[64:67]
s_nop 7
    ds_write_b128 v9, v[64:67]
    s_waitcnt lgkmcnt(0)
    s_barrier
    s_cmp_lg_u32 s38, 0
    s_cbranch_scc1 Lga_34
    ds_read_b128 v[48:51], v8 offset:0
    ds_read_b128 v[52:55], v8 offset:128
    ds_read_b128 v[56:59], v8 offset:256
    ds_read_b128 v[60:63], v8 offset:384
    v_and_b32 v70, 1, v0
    v_lshrrev_b32 v71, 4, v0
    v_lshlrev_b32 v71, 4, v71
    v_lshl_add_u32 v70, v70, 6, v71
    s_add_u32 s54, s72, s46
    s_waitcnt lgkmcnt(0)
    v_add_f32 v48, v48, v52
    v_add_f32 v56, v56, v60
    v_add_f32 v49, v49, v53
    v_add_f32 v57, v57, v61
    v_add_f32 v50, v50, v54
    v_add_f32 v58, v58, v62
    v_add_f32 v51, v51, v55
    v_add_f32 v59, v59, v63
    v_add_f32 v48, v48, v56
    v_add_f32 v49, v49, v57
    v_add_f32 v50, v50, v58
    v_add_f32 v51, v51, v59
    s_mov_b64 exec, s[68:69]
    buffer_store_dwordx4 v[48:51], v70, s[12:15], s54 offen offset:3072 sc1
    s_mov_b64 exec, -1
Lga_34:
    s_cmp_lt_u32 s2, 112
    s_cbranch_scc1 L_FFN
    s_cmp_ge_u32 s2, 224
    s_cbranch_scc1 L_RED
    s_cmp_eq_u32 s99, 2
    s_cbranch_scc1 L_end
    s_cmp_lg_u32 s99, 0
    s_cbranch_scc1 L_G2
    s_cmp_eq_u32 s38, 0
    s_cbranch_scc1 Ltp_35
    s_load_dwordx2 s[16:17], s[0:1], 8
    s_lshr_b32 s54, s2, 3
    s_sub_u32 s54, s54, 14
    s_mul_i32 s54, s54, 3
    s_add_u32 s54, s54, s38
    s_sub_u32 s54, s54, 1
    s_and_b32 s55, s2, 7
    s_lshl_b32 s55, s55, 23
    s_mul_i32 s56, s38, 1152
    s_add_u32 m0, s56, 147456
    v_lshlrev_b32 v70, 6, v0
    s_waitcnt lgkmcnt(0)
    s_and_b32 s17, s17, 0xffff
    s_mov_b32 s18, 134217728
    s_mov_b32 s19, 0x20000
Ltpl_36:
    s_bfe_u32 s56, s54, 0x20004
    s_lshl_b32 s56, s56, 21
    s_bfe_i32 s57, s54, 0x10000
    s_and_b32 s65, s57, 32768
    s_bfe_i32 s57, s54, 0x10001
    s_and_b32 s57, s57, 1572864
    s_xor_b32 s65, s65, s57
    s_bfe_i32 s57, s54, 0x10002
    s_and_b32 s57, s57, 282624
    s_xor_b32 s65, s65, s57
    s_bfe_i32 s57, s54, 0x10003
    s_and_b32 s57, s57, 2015232
    s_xor_b32 s65, s65, s57
    s_bfe_i32 s57, s54, 0x10006
    s_and_b32 s57, s57, 323584
    s_xor_b32 s65, s65, s57
    s_bfe_i32 s57, s54, 0x10007
    s_and_b32 s57, s57, 303104
    s_xor_b32 s65, s65, s57
    s_bfe_i32 s57, s54, 0x10008
    s_and_b32 s57, s57, 933888
    s_xor_b32 s65, s65, s57
    s_bfe_i32 s57, s54, 0x10009
    s_and_b32 s57, s57, 229376
    s_xor_b32 s65, s65, s57
    s_xor_b32 s57, s65, 67108864
    s_add_u32 s56, s56, s57
    s_add_u32 s56, s56, s55
    s_waitcnt vmcnt(3)
    buffer_load_dword v70, s[16:19], s56 offen  lds
    s_add_u32 s54, s54, 42
    s_cmp_lt_u32 s54, 512
    s_cbranch_scc1 Ltpl_36
Ltp_35:
    s_branch L_G2
L_FFN:
    s_mov_b32 s16, s26
    s_and_b32 s17, s27, 0xffff
    s_mov_b32 s18, 1835008
    s_mov_b32 s19, 0x20000
    v_lshrrev_b32 v2, 4, v0
    v_lshlrev_b32 v2, 10, v2
    v_and_b32 v3, 15, v0
    v_lshl_add_u32 v2, v3, 4, v2
    s_lshl_b32 s54, s2, 14
    s_lshl_b32 s55, s38, 8
    s_add_u32 s54, s54, s55
    s_add_u32 m0, s44, 0
s_nop 0
    buffer_load_dwordx4 v2, s[16:19], s54 offen lds
    s_add_u32 m0, s44, 1024
    s_add_u32 s54, s54, 4096
    buffer_load_dwordx4 v2, s[16:19], s54 offen lds
    s_add_u32 m0, s44, 2048
    s_add_u32 s54, s54, 4096
    buffer_load_dwordx4 v2, s[16:19], s54 offen lds
    s_add_u32 m0, s44, 3072
    s_add_u32 s54, s54, 4096
    buffer_load_dwordx4 v2, s[16:19], s54 offen lds
    s_mov_b32 s16, s28
    s_and_b32 s17, s29, 0xffff
    s_mov_b32 s18, 3584
    s_mov_b32 s19, 0x20000
    v_lshrrev_b32 v3, 4, v0
    v_lshlrev_b32 v3, 3, v3
    s_lshl_b32 s54, s2, 5
    buffer_load_dwordx2 v[4:5], v3, s[16:19], s54 offen
    v_lshrrev_b32 v2, 4, v0
    v_lshlrev_b32 v2, 2, v2
    v_bfe_u32 v3, v0, 2, 2
    v_add_u32 v2, v2, v3
    v_lshlrev_b32 v2, 8, v2
    v_and_b32 v3, 3, v0
    v_lshl_add_u32 v2, v3, 3, v2
    v_add_u32 v2, s44, v2
    v_mov_b32 v69, v2
    v_lshrrev_b32 v10, 5, v0
    v_lshlrev_b32 v10, 15, v10
    v_and_b32 v11, 31, v0
    v_lshl_add_u32 v10, v11, 4, v10
    s_and_b32 s54, s38, 1
    s_lshl_b32 s54, s54, 16
    s_lshr_b32 s55, s99, 1
    s_lshl_b32 s55, s55, 9
    s_add_u32 s54, s54, s55
    s_add_u32 s54, s54, s100
    s_lshr_b32 s55, s38, 1
    s_cmp_gt_u32 s99, s55
    s_cselect_b32 s101, 1, 0
    s_lshl_b32 s55, s38, 9
    s_add_u32 s55, s55, 157888
    v_lshlrev_b32 v11, 3, v0
    v_add_u32 v11, s55, v11
    v_and_b32 v12, 1, v0
    v_lshlrev_b32 v13, 10, v12
    v_and_b32 v14, 48, v0
    v_add_u32 v13, v13, v14
    s_lshl_b32 s55, s38, 8
    s_add_u32 s55, s55, 157888
    v_add_u32 v13, s55, v13
    v_lshlrev_b32 v14, 1, v14
    v_lshl_add_u32 v14, v12, 4, v14
    v_add_u32 v14, 159936, v14
    s_lshl_b32 s55, s38, 7
    v_add_u32 v15, s55, v14
    s_waitcnt lgkmcnt(0)
    v_mov_b32 v64, 0
    v_mov_b32 v65, 0
    v_mov_b32 v66, 0
    v_mov_b32 v67, 0
    v_mov_b32 v8, 0
    v_mov_b32 v9, 0
    s_cmp_lg_u32 s101, 0
    s_cbranch_scc1 Lres_37
    s_mov_b32 s16, s36
    s_and_b32 s17, s37, 0xffff
    s_mov_b32 s18, 2048
    s_mov_b32 s19, 0x20000
    v_lshlrev_b32 v70, 3, v0
    s_and_b32 s55, s38, 1
    s_lshl_b32 s55, s55, 9
    s_lshl_b32 s56, s99, 10
    s_add_u32 s55, s55, s56
    buffer_load_dwordx2 v[8:9], v70, s[16:19], s55 offen
Lres_37:
    v_lshrrev_b32 v6, 2, v0
    v_lshlrev_b32 v6, 17, v6
    v_and_b32 v7, 3, v0
    v_lshl_add_u32 v6, v7, 4, v6
    s_and_b32 s55, s38, 1
    s_lshl_b32 s55, s55, 21
    s_lshr_b32 s56, s38, 1
    s_lshl_b32 s56, s56, 6
    s_add_u32 s55, s55, s56
    s_add_u32 s55, s55, s46
    s_mov_b32 s48, 200000
Lpoll_38:
    buffer_load_dwordx4 v[48:51], v6, s[12:15], s55 offen offset:3072 sc1
    s_add_u32 s56, s55, 16384
    buffer_load_dwordx4 v[52:55], v6, s[12:15], s56 offen offset:3072 sc1
    s_add_u32 s56, s55, 32768
    buffer_load_dwordx4 v[56:59], v6, s[12:15], s56 offen offset:3072 sc1
    s_add_u32 s56, s55, 49152
    buffer_load_dwordx4 v[60:63], v6, s[12:15], s56 offen offset:3072 sc1
    s_add_u32 s56, s55, 65536
    buffer_load_dwordx4 v[16:19], v6, s[12:15], s56 offen offset:3072 sc1
    s_add_u32 s56, s55, 81920
    buffer_load_dwordx4 v[20:23], v6, s[12:15], s56 offen offset:3072 sc1
    s_add_u32 s56, s55, 98304
    buffer_load_dwordx4 v[24:27], v6, s[12:15], s56 offen offset:3072 sc1
    s_add_u32 s56, s55, 114688
    buffer_load_dwordx4 v[28:31], v6, s[12:15], s56 offen offset:3072 sc1
    s_cmp_eq_u32 s101, 0
    s_cbranch_scc1 Lres_39
    buffer_load_dwordx4 v[64:67], v10, s[12:15], s54 offen offset:2048 sc1
Lres_39:
    s_waitcnt vmcnt(0)
    v_max3_u32 v70, v48, v49, v50
    v_max3_u32 v70, v70, v51, v52
    v_max3_u32 v70, v70, v53, v54
    v_max3_u32 v70, v70, v55, v56
    v_max3_u32 v70, v70, v57, v58
    v_max3_u32 v70, v70, v59, v60
    v_max3_u32 v70, v70, v61, v62
    v_max3_u32 v70, v70, v63, v16
    v_max3_u32 v70, v70, v17, v18
    v_max3_u32 v70, v70, v19, v20
    v_max3_u32 v70, v70, v21, v22
    v_max3_u32 v70, v70, v23, v24
    v_max3_u32 v70, v70, v25, v26
    v_max3_u32 v70, v70, v27, v28
    v_max3_u32 v70, v70, v29, v30
    v_max3_u32 v70, v70, v31, v64
    v_max3_u32 v70, v70, v65, v66
    v_max_u32 v70, v70, v67
    v_cmp_eq_u32 vcc, -1, v70
    s_cbranch_vccz Lok_40
    s_sub_u32 s48, s48, 1
    s_cmp_lg_u32 s48, 0
    s_cbranch_scc1 Lpoll_38
Lok_40:
    v_add_f32 v48, v48, v52
    v_add_f32 v56, v56, v60
    v_add_f32 v16, v16, v20
    v_add_f32 v24, v24, v28
    v_add_f32 v49, v49, v53
    v_add_f32 v57, v57, v61
    v_add_f32 v17, v17, v21
    v_add_f32 v25, v25, v29
    v_add_f32 v50, v50, v54
    v_add_f32 v58, v58, v62
    v_add_f32 v18, v18, v22
    v_add_f32 v26, v26, v30
    v_add_f32 v51, v51, v55
    v_add_f32 v59, v59, v63
    v_add_f32 v19, v19, v23
    v_add_f32 v27, v27, v31
    v_add_f32 v48, v48, v56
    v_add_f32 v16, v16, v24
    v_add_f32 v49, v49, v57
    v_add_f32 v17, v17, v25
    v_add_f32 v50, v50, v58
    v_add_f32 v18, v18, v26
    v_add_f32 v51, v51, v59
    v_add_f32 v19, v19, v27
    v_lshlrev_b32 v6, 16, v8
    v_and_b32 v7, 0xffff0000, v8
    v_lshlrev_b32 v8, 16, v9
    v_and_b32 v9, 0xffff0000, v9
    v_add_f32 v48, v48, v16
    v_add_f32 v64, v64, v6
    v_add_f32 v49, v49, v17
    v_add_f32 v65, v65, v7
    v_add_f32 v50, v50, v18
    v_add_f32 v66, v66, v8
    v_add_f32 v51, v51, v19
    v_add_f32 v67, v67, v9
    v_add_f32 v48, v48, v64
    v_add_f32 v49, v49, v65
    v_add_f32 v50, v50, v66
    v_add_f32 v51, v51, v67
    ds_read_b64_tr_b16 v[16:17], v69 offset:0
    ds_read_b64_tr_b16 v[18:19], v69 offset:32
    ds_read_b64_tr_b16 v[20:21], v69 offset:64
    ds_read_b64_tr_b16 v[22:23], v69 offset:96
    ds_read_b64_tr_b16 v[24:25], v69 offset:128
    ds_read_b64_tr_b16 v[26:27], v69 offset:160
    ds_read_b64_tr_b16 v[28:29], v69 offset:192
    ds_read_b64_tr_b16 v[30:31], v69 offset:224
    v_lshlrev_b32 v2, 16, v4
    v_and_b32 v3, 0xffff0000, v4
    v_lshlrev_b32 v4, 16, v5
    v_and_b32 v5, 0xffff0000, v5
    v_cvt_pk_bf16_f32 v52, v48, v49
    v_cvt_pk_bf16_f32 v53, v50, v51
    ds_write_b64 v11, v[52:53]
    v_lshlrev_b32 v48, 16, v52
    v_and_b32 v49, 0xffff0000, v52
    v_lshlrev_b32 v50, 16, v53
    v_and_b32 v51, 0xffff0000, v53
    v_add_f32 v68, v48, v49
    v_mul_f32 v69, v48, v48
    v_add_f32 v68, v68, v50
    v_fmac_f32 v69, v49, v49
    v_add_f32 v68, v68, v51
    v_fmac_f32 v69, v50, v50
    v_fmac_f32 v69, v51, v51
    s_waitcnt lgkmcnt(0)
    s_barrier
    ds_read_b128 v[48:51], v13 offset:0
    ds_read_b128 v[52:55], v13 offset:64
    ds_read_b128 v[56:59], v13 offset:128
    ds_read_b128 v[60:63], v13 offset:192
    v_and_b32 v10, 48, v0
    v_add_u32 v10, 160512, v10
    ds_read_b128 v[6:9], v10
    v_add_f32_dpp v68, v68, v68 row_ror:8 row_mask:0xf bank_mask:0xf
    v_add_f32_dpp v69, v69, v69 row_ror:8 row_mask:0xf bank_mask:0xf
s_nop 0
    v_add_f32_dpp v68, v68, v68 row_ror:4 row_mask:0xf bank_mask:0xf
    v_add_f32_dpp v69, v69, v69 row_ror:4 row_mask:0xf bank_mask:0xf
s_nop 0
    v_add_f32_dpp v68, v68, v68 row_ror:2 row_mask:0xf bank_mask:0xf
    v_add_f32_dpp v69, v69, v69 row_ror:2 row_mask:0xf bank_mask:0xf
s_nop 0
    v_add_f32_dpp v68, v68, v68 row_ror:1 row_mask:0xf bank_mask:0xf
    v_add_f32_dpp v69, v69, v69 row_ror:1 row_mask:0xf bank_mask:0xf
    v_mov_b32 v70, v68
    v_mov_b32 v71, v69
s_nop 0
    v_permlane16_swap_b32 v70, v68
    v_permlane16_swap_b32 v71, v69
    v_add_f32 v68, v70, v68
    v_add_f32 v69, v71, v69
    v_mov_b32 v70, v68
    v_mov_b32 v71, v69
s_nop 0
    v_permlane32_swap_b32 v70, v68
    v_permlane32_swap_b32 v71, v69
    v_add_f32 v68, v70, v68
    v_add_f32 v69, v71, v69
    s_waitcnt lgkmcnt(0)
    v_mfma_f32_16x16x32_bf16 v[64:67], v[32:35], v[48:51], 0
    v_mfma_f32_16x16x32_bf16 v[64:67], v[36:39], v[52:55], v[64:67]
    v_mfma_f32_16x16x32_bf16 v[64:67], v[40:43], v[56:59], v[64:67]
    v_mfma_f32_16x16x32_bf16 v[64:67], v[44:47], v[60:63], v[64:67]
    s_lshl_b32 s55, s38, 3
    s_add_u32 s55, s55, 160448
    v_mov_b32 v70, s55
    ds_write_b64 v70, v[68:69]
    ds_read_b128 v[52:55], v10 offset:64
    ds_read_b128 v[56:59], v10 offset:128
    ds_read_b128 v[60:63], v10 offset:192
s_nop 0
    ds_write_b128 v15, v[64:67]
    s_waitcnt lgkmcnt(0)
    v_add_f32 v6, v6, v52
    v_add_f32 v7, v7, v53
    v_add_f32 v8, v8, v54
    v_add_f32 v9, v9, v55
    v_add_f32 v6, v6, v56
    v_add_f32 v7, v7, v57
    v_add_f32 v8, v8, v58
    v_add_f32 v9, v9, v59
    v_add_f32 v6, v6, v60
    v_add_f32 v7, v7, v61
    v_add_f32 v8, v8, v62
    v_add_f32 v9, v9, v63
    s_barrier
    ds_read_b128 v[48:51], v14 offset:0
    ds_read_b128 v[52:55], v14 offset:128
    ds_read_b128 v[56:59], v14 offset:256
    ds_read_b128 v[60:63], v14 offset:384
    v_lshlrev_b32 v70, 4, v12
    v_add_u32 v70, 160448, v70
    ds_read_b128 v[64:67], v70
    s_waitcnt lgkmcnt(0)
    v_add_f32 v68, v64, v66
    v_add_f32 v69, v65, v67
    v_mul_f32 v68, 0x3b000000, v68
    v_mul_f32 v69, 0x3b000000, v69
    v_fma_f32 v69, -v68, v68, v69
    v_max_f32 v69, 0, v69
    v_add_f32 v69, 0x3727c5ac, v69
    v_rsq_f32 v69, v69
    v_add_f32 v48, v48, v52
    v_add_f32 v56, v56, v60
    v_add_f32 v49, v49, v53
    v_add_f32 v57, v57, v61
    v_add_f32 v50, v50, v54
    v_add_f32 v58, v58, v62
    v_add_f32 v51, v51, v55
    v_add_f32 v59, v59, v63
    v_add_f32 v48, v48, v56
    v_add_f32 v49, v49, v57
    v_add_f32 v50, v50, v58
    v_add_f32 v51, v51, v59
    v_fma_f32 v48, -v68, v6, v48
    v_fma_f32 v49, -v68, v7, v49
    v_fma_f32 v50, -v68, v8, v50
    v_fma_f32 v51, -v68, v9, v51
    v_fma_f32 v48, v69, v48, v2
    v_fma_f32 v49, v69, v49, v3
    v_fma_f32 v50, v69, v50, v4
    v_fma_f32 v51, v69, v51, v5
    s_mov_b32 s55, 0x3d372713
    s_mov_b32 s56, 0xc0135761
    v_mul_f32 v52, v48, v48
    v_mul_f32 v53, v49, v49
    v_mul_f32 v54, v50, v50
    v_mul_f32 v55, v51, v51
    v_fma_f32 v52, v52, s55, 1.0
    v_fma_f32 v53, v53, s55, 1.0
    v_fma_f32 v54, v54, s55, 1.0
    v_fma_f32 v55, v55, s55, 1.0
    v_mul_f32 v52, v52, v48
    v_mul_f32 v53, v53, v49
    v_mul_f32 v54, v54, v50
    v_mul_f32 v55, v55, v51
    v_mul_f32 v52, s56, v52
    v_mul_f32 v53, s56, v53
    v_mul_f32 v54, s56, v54
    v_mul_f32 v55, s56, v55
    v_exp_f32 v52, v52
    v_exp_f32 v53, v53
    v_exp_f32 v54, v54
    v_exp_f32 v55, v55
    v_add_f32 v52, 1.0, v52
    v_add_f32 v53, 1.0, v53
    v_add_f32 v54, 1.0, v54
    v_add_f32 v55, 1.0, v55
    v_rcp_f32 v52, v52
    v_rcp_f32 v53, v53
    v_rcp_f32 v54, v54
    v_rcp_f32 v55, v55
    v_mul_f32 v48, v48, v52
    v_mul_f32 v49, v49, v53
    v_mul_f32 v50, v50, v54
    v_mul_f32 v51, v51, v55
    v_cvt_pk_bf16_f32 v56, v48, v49
    v_cvt_pk_bf16_f32 v57, v50, v51
    v_lshlrev_b32 v10, 11, v12
    v_bfe_u32 v11, v0, 1, 3
    v_lshl_add_u32 v10, v11, 6, v10
    v_and_b32 v11, 48, v0
    v_add_u32 v10, v10, v11
    s_lshl_b32 s54, s38, 9
    s_add_u32 s54, s54, s72
    s_add_u32 s54, s54, s46
    s_add_u32 s54, s54, 4096
    s_lshl_b64 s[52:53], s[68:69], 0
    v_cndmask_b32 v58, 0, v56, s[52:53]
    v_cndmask_b32 v59, 0, v57, s[52:53]
    s_lshl_b64 s[52:53], s[68:69], 2
    v_cndmask_b32 v60, 0, v56, s[52:53]
    v_cndmask_b32 v61, 0, v57, s[52:53]
    v_mfma_f32_16x16x16_bf16 v[64:67], v[16:17], v[58:59], 0
    s_lshl_b64 s[52:53], s[68:69], 4
    v_cndmask_b32 v58, 0, v56, s[52:53]
    v_cndmask_b32 v59, 0, v57, s[52:53]
    v_mfma_f32_16x16x16_bf16 v[64:67], v[18:19], v[60:61], v[64:67]
    s_lshl_b64 s[52:53], s[68:69], 6
    v_cndmask_b32 v60, 0, v56, s[52:53]
    v_cndmask_b32 v61, 0, v57, s[52:53]
    v_mfma_f32_16x16x16_bf16 v[64:67], v[20:21], v[58:59], v[64:67]
    s_lshl_b64 s[52:53], s[68:69], 8
    v_cndmask_b32 v58, 0, v56, s[52:53]
    v_cndmask_b32 v59, 0, v57, s[52:53]
    v_mfma_f32_16x16x16_bf16 v[64:67], v[22:23], v[60:61], v[64:67]
    s_lshl_b64 s[52:53], s[68:69], 10
    v_cndmask_b32 v60, 0, v56, s[52:53]
    v_cndmask_b32 v61, 0, v57, s[52:53]
    v_mfma_f32_16x16x16_bf16 v[64:67], v[24:25], v[58:59], v[64:67]
    s_lshl_b64 s[52:53], s[68:69], 12
    v_cndmask_b32 v58, 0, v56, s[52:53]
    v_cndmask_b32 v59, 0, v57, s[52:53]
    v_mfma_f32_16x16x16_bf16 v[64:67], v[26:27], v[60:61], v[64:67]
    s_lshl_b64 s[52:53], s[68:69], 14
    v_cndmask_b32 v60, 0, v56, s[52:53]
    v_cndmask_b32 v61, 0, v57, s[52:53]
    v_mfma_f32_16x16x16_bf16 v[64:67], v[28:29], v[58:59], v[64:67]
s_nop 0
    v_mfma_f32_16x16x16_bf16 v[64:67], v[30:31], v[60:61], v[64:67]
    s_cmp_lg_u32 s99, 2
    s_cselect_b32 s55, s47, 0
    s_cmp_eq_u32 s55, 0
    s_cbranch_scc1 Lfg_41
s_nop 3
    buffer_store_dwordx4 v[64:67], v10, s[12:15], s54 offen
    s_branch Lfj_42
Lfg_41:
s_nop 3
    buffer_store_dwordx4 v[64:67], v10, s[12:15], s54 offen sc1
Lfj_42:
    s_cmp_eq_u32 s99, 2
    s_cbranch_scc1 L_end
    s_mov_b32 s16, s20
    s_and_b32 s17, s21, 0xffff
    s_mov_b32 s18, 4194304
    s_mov_b32 s19, 0x20000
    s_mov_b32 s55, 8192
    s_lshr_b32 s56, s40, 1
    s_lshl_b32 s56, s56, 20
    s_lshl_b32 s57, s39, 8
    s_add_u32 s56, s56, s57
    s_and_b32 s57, s40, 1
    s_lshl_b32 s57, s57, 7
    s_add_u32 s56, s56, s57
    s_lshl_b32 s57, s38, 5
    s_add_u32 s56, s56, s57
    v_lshrrev_b32 v70, 1, v0
    v_mul_lo_u32 v70, v70, s55
    v_and_b32 v71, 1, v0
    v_lshl_add_u32 v70, v71, 4, v70
    s_lshl_b32 s57, s55, 5
    s_add_u32 m0, s44, 0
s_nop 0
    buffer_load_dwordx4 v70, s[16:19], s56 offen lds
    s_add_u32 m0, s44, 1024
    s_add_u32 s56, s56, s57
    buffer_load_dwordx4 v70, s[16:19], s56 offen lds
    s_add_u32 m0, s44, 2048
    s_add_u32 s56, s56, s57
    buffer_load_dwordx4 v70, s[16:19], s56 offen lds
    s_add_u32 m0, s44, 3072
    s_add_u32 s56, s56, s57
    buffer_load_dwordx4 v70, s[16:19], s56 offen lds
    s_waitcnt vmcnt(0)
    v_lshrrev_b32 v70, 4, v0
    v_lshlrev_b32 v70, 3, v70
    v_bfe_u32 v71, v0, 2, 2
    v_add_u32 v70, v70, v71
    v_lshlrev_b32 v70, 5, v70
    v_and_b32 v71, 3, v0
    v_lshl_add_u32 v70, v71, 3, v70
    v_add_u32 v70, s44, v70
    ds_read_b64_tr_b16 v[32:33], v70 offset:0
    ds_read_b64_tr_b16 v[34:35], v70 offset:128
    ds_read_b64_tr_b16 v[36:37], v70 offset:1024
    ds_read_b64_tr_b16 v[38:39], v70 offset:1152
    ds_read_b64_tr_b16 v[40:41], v70 offset:2048
    ds_read_b64_tr_b16 v[42:43], v70 offset:2176
    ds_read_b64_tr_b16 v[44:45], v70 offset:3072
    ds_read_b64_tr_b16 v[46:47], v70 offset:3200
    s_waitcnt lgkmcnt(0)
    s_branch L_G2
L_RED:
    s_cmp_lg_u32 s99, 2
    s_cbranch_scc1 L_PRE
    s_sub_u32 s64, s2, 224
    s_lshr_b32 s65, s64, 4
    s_and_b32 s49, s64, 15
    s_mov_b32 s16, s30
    s_and_b32 s17, s31, 0xffff
    s_mov_b32 s18, 1024
    s_mov_b32 s19, 0x20000
    v_and_b32 v2, 7, v0
    v_lshlrev_b32 v3, 3, v2
    s_lshl_b32 s54, s49, 6
    buffer_load_dwordx2 v[4:5], v3, s[16:19], s54 offen
    v_lshrrev_b32 v6, 3, v0
    s_cmp_lg_u32 s38, 0
    s_cbranch_scc1 Lr1_43
    v_lshlrev_b32 v7, 14, v6
    v_lshrrev_b32 v70, 2, v2
    v_lshl_add_u32 v7, v70, 17, v7
    v_and_b32 v70, 3, v2
    v_lshl_add_u32 v7, v70, 4, v7
    s_lshl_b32 s54, s49, 18
    s_add_u32 s54, s54, s46
    s_lshl_b32 s55, s65, 6
    s_add_u32 s54, s54, s55
    v_lshlrev_b32 v71, 4, v2
    s_lshr_b32 s55, s49, 2
    s_lshl_b32 s55, s55, 15
    s_and_b32 s56, s49, 3
    s_lshl_b32 s56, s56, 7
    s_add_u32 s55, s55, s56
    s_add_u32 s55, s55, 512
    s_add_u32 s55, s55, s100
    v_mov_b32 v8, v71
    v_add_u32 v71, 157760, v71
    s_mov_b32 s48, 200000
Lpoll_44:
    buffer_load_dwordx4 v[48:51], v7, s[12:15], s54 offen offset:3072 sc1
    buffer_load_dwordx4 v[64:67], v8, s[12:15], s55 offen offset:2048 sc1
    s_waitcnt vmcnt(0)
    v_max3_u32 v70, v48, v49, v50
    v_max3_u32 v70, v70, v51, v64
    v_max3_u32 v70, v70, v65, v66
    v_max_u32 v70, v70, v67
    v_cmp_eq_u32 vcc, -1, v70
    s_cbranch_vccz Lok_45
    s_sub_u32 s48, s48, 1
    s_cmp_lg_u32 s48, 0
    s_cbranch_scc1 Lpoll_44
Lok_45:
    v_add_f32_dpp v48, v48, v48 row_ror:8 row_mask:0xf bank_mask:0xf
    v_add_f32_dpp v49, v49, v49 row_ror:8 row_mask:0xf bank_mask:0xf
    v_add_f32_dpp v50, v50, v50 row_ror:8 row_mask:0xf bank_mask:0xf
    v_add_f32_dpp v51, v51, v51 row_ror:8 row_mask:0xf bank_mask:0xf
    v_mov_b32 v52, v48
    v_mov_b32 v53, v49
    v_mov_b32 v54, v50
    v_mov_b32 v55, v51
    v_permlane16_swap_b32 v52, v48
    v_permlane16_swap_b32 v53, v49
    v_permlane16_swap_b32 v54, v50
    v_permlane16_swap_b32 v55, v51
    v_add_f32 v48, v52, v48
    v_add_f32 v49, v53, v49
    v_add_f32 v50, v54, v50
    v_add_f32 v51, v55, v51
    v_mov_b32 v52, v48
    v_mov_b32 v53, v49
    v_mov_b32 v54, v50
    v_mov_b32 v55, v51
    v_permlane32_swap_b32 v52, v48
    v_permlane32_swap_b32 v53, v49
    v_permlane32_swap_b32 v54, v50
    v_permlane32_swap_b32 v55, v51
    v_add_f32 v48, v52, v48
    v_add_f32 v49, v53, v49
    v_add_f32 v50, v54, v50
    v_add_f32 v51, v55, v51
    s_waitcnt lgkmcnt(0)
    v_add_f32 v48, v48, v64
    v_add_f32 v49, v49, v65
    v_add_f32 v50, v50, v66
    v_add_f32 v51, v51, v67
    ds_write_b128 v71, v[48:51]
Lr1_43:
    v_lshlrev_b32 v7, 14, v6
    v_lshl_add_u32 v7, v2, 4, v7
    s_lshl_b32 s54, s38, 17
    s_add_u32 s54, s54, s46
    s_lshl_b32 s55, s65, 11
    s_add_u32 s54, s54, s55
    s_lshl_b32 s55, s49, 7
    s_add_u32 s54, s54, s55
    s_add_u32 s54, s54, 4096
    s_add_u32 s55, s54, 524288
    s_add_u32 s56, s54, 1048576
    s_add_u32 s57, s54, 1572864
    v_mov_b32 v60, 0
    v_mov_b32 v61, 0
    v_mov_b32 v62, 0
    v_mov_b32 v63, 0
    s_mov_b32 s48, 200000
Lpoll_46:
    buffer_load_dwordx4 v[48:51], v7, s[12:15], s54 offen sc1
    buffer_load_dwordx4 v[52:55], v7, s[12:15], s55 offen sc1
    buffer_load_dwordx4 v[56:59], v7, s[12:15], s56 offen sc1
    s_cmp_ge_u32 s38, 2
    s_cbranch_scc1 Lr3_47
    buffer_load_dwordx4 v[60:63], v7, s[12:15], s57 offen sc1
Lr3_47:
    s_waitcnt vmcnt(0)
    v_max3_u32 v70, v48, v49, v50
    v_max3_u32 v70, v70, v51, v52
    v_max3_u32 v70, v70, v53, v54
    v_max3_u32 v70, v70, v55, v56
    v_max3_u32 v70, v70, v57, v58
    v_max3_u32 v70, v70, v59, v60
    v_max3_u32 v70, v70, v61, v62
    v_max_u32 v70, v70, v63
    v_cmp_eq_u32 vcc, -1, v70
    s_cbranch_vccz Lok_48
    s_sub_u32 s48, s48, 1
    s_cmp_lg_u32 s48, 0
    s_cbranch_scc1 Lpoll_46
Lok_48:
    v_add_f32 v48, v48, v52
    v_add_f32 v56, v56, v60
    v_add_f32 v49, v49, v53
    v_add_f32 v57, v57, v61
    v_add_f32 v50, v50, v54
    v_add_f32 v58, v58, v62
    v_add_f32 v51, v51, v55
    v_add_f32 v59, v59, v63
    v_add_f32 v48, v48, v56
    v_add_f32 v49, v49, v57
    v_add_f32 v50, v50, v58
    v_add_f32 v51, v51, v59
    v_add_f32_dpp v48, v48, v48 row_ror:8 row_mask:0xf bank_mask:0xf
    v_add_f32_dpp v49, v49, v49 row_ror:8 row_mask:0xf bank_mask:0xf
    v_add_f32_dpp v50, v50, v50 row_ror:8 row_mask:0xf bank_mask:0xf
    v_add_f32_dpp v51, v51, v51 row_ror:8 row_mask:0xf bank_mask:0xf
    v_mov_b32 v52, v48
    v_mov_b32 v53, v49
    v_mov_b32 v54, v50
    v_mov_b32 v55, v51
    v_permlane16_swap_b32 v52, v48
    v_permlane16_swap_b32 v53, v49
    v_permlane16_swap_b32 v54, v50
    v_permlane16_swap_b32 v55, v51
    v_add_f32 v48, v52, v48
    v_add_f32 v49, v53, v49
    v_add_f32 v50, v54, v50
    v_add_f32 v51, v55, v51
    v_mov_b32 v52, v48
    v_mov_b32 v53, v49
    v_mov_b32 v54, v50
    v_mov_b32 v55, v51
    v_permlane32_swap_b32 v52, v48
    v_permlane32_swap_b32 v53, v49
    v_permlane32_swap_b32 v54, v50
    v_permlane32_swap_b32 v55, v51
    v_add_f32 v48, v52, v48
    v_add_f32 v49, v53, v49
    v_add_f32 v50, v54, v50
    v_add_f32 v51, v55, v51
    s_lshl_b32 s54, s38, 7
    s_add_u32 s54, s54, 159936
    v_and_b32 v70, 7, v0
    v_lshlrev_b32 v70, 4, v70
    v_add_u32 v71, s54, v70
    ds_write_b128 v71, v[48:51]
    s_waitcnt lgkmcnt(0)
    s_barrier
    s_cmp_lg_u32 s38, 0
    s_cbranch_scc1 Lr4_49
    v_add_u32 v71, 159936, v70
    ds_read_b128 v[48:51], v71 offset:0
    ds_read_b128 v[52:55], v71 offset:128
    ds_read_b128 v[56:59], v71 offset:256
    ds_read_b128 v[60:63], v71 offset:384
    v_add_u32 v70, 157760, v70
    ds_read_b128 v[64:67], v70
    s_waitcnt lgkmcnt(0)
    v_add_f32 v48, v48, v52
    v_add_f32 v56, v56, v60
    v_add_f32 v49, v49, v53
    v_add_f32 v57, v57, v61
    v_add_f32 v50, v50, v54
    v_add_f32 v58, v58, v62
    v_add_f32 v51, v51, v55
    v_add_f32 v59, v59, v63
    v_add_f32 v48, v48, v56
    v_add_f32 v49, v49, v57
    v_add_f32 v50, v50, v58
    v_add_f32 v51, v51, v59
    v_add_f32 v48, v48, v64
    v_add_f32 v49, v49, v65
    v_add_f32 v50, v50, v66
    v_add_f32 v51, v51, v67
    v_lshlrev_b32 v52, 16, v4
    v_and_b32 v53, 0xffff0000, v4
    v_lshlrev_b32 v54, 16, v5
    v_and_b32 v55, 0xffff0000, v5
    v_add_f32 v48, v48, v52
    v_add_f32 v49, v49, v53
    v_add_f32 v50, v50, v54
    v_add_f32 v51, v51, v55
    s_mov_b64 s[50:51], exec
    s_cmp_eq_u32 s65, 0
    s_cbranch_scc1 L_end
    s_branch Lout_50
    ds_write_b128 v70, v[48:51]
    s_add_u32 s54, s72, s46
    v_lshlrev_b32 v3, 4, v2
    s_mov_b64 exec, 0xff
    buffer_store_dwordx4 v[48:51], v3, s[12:15], s54 offen offset:3200 sc1
    s_mov_b64 exec, s[50:51]
    s_waitcnt lgkmcnt(0)
    s_branch L_G2
Lout_50:
    s_mov_b32 s16, s32
    s_and_b32 s17, s33, 0xffff
    s_mov_b32 s18, 2048
    s_mov_b32 s19, 0x20000
    v_cvt_pk_bf16_f32 v52, v48, v49
    v_cvt_pk_bf16_f32 v53, v50, v51
    s_lshl_b32 s54, s64, 6
    v_lshlrev_b32 v3, 3, v2
    s_mov_b64 exec, 0xff
    buffer_store_dwordx2 v[52:53], v3, s[16:19], s54 offen
    s_waitcnt vmcnt(0)
    s_branch L_end
Lr4_49:
    s_branch L_end
L_PRE:
    s_sub_u32 s64, s2, 224
    s_lshr_b32 s64, s64, 3
    s_lshr_b32 s65, s64, 1
    s_and_b32 s49, s64, 1
    s_lshl_b32 s49, s49, 2
    s_add_u32 s49, s49, s38
    v_lshrrev_b32 v2, 4, v0
    v_and_b32 v3, 15, v0
    v_lshlrev_b32 v6, 17, v2
    v_lshl_add_u32 v6, v3, 4, v6
    s_lshl_b32 s54, s65, 11
    s_lshl_b32 s55, s49, 8
    s_add_u32 s54, s54, s55
    s_add_u32 s54, s54, 4096
    s_add_u32 s54, s54, s46
    s_add_u32 s55, s54, 1572864
    v_add_u32 v7, s55, v6
    v_lshrrev_b32 v8, 2, v3
    s_lshl_b32 s55, s49, 2
    v_add_u32 v8, s55, v8
    v_lshlrev_b32 v8, 17, v8
    v_and_b32 v9, 3, v3
    v_lshl_add_u32 v8, v9, 4, v8
    s_lshl_b32 s55, s65, 6
    s_add_u32 s55, s55, 3072
    s_add_u32 s55, s55, s46
    v_add_u32 v8, s55, v8
    v_cmp_gt_u32 vcc, 2, v2
s_nop 1
    v_cndmask_b32 v7, v8, v7, vcc
    s_and_b32 s57, s2, 7
    s_lshl_b32 s57, s57, 14
    s_add_u32 s54, s54, s57
    s_add_u32 s55, s54, 524288
    s_add_u32 s56, s54, 1048576
    v_mov_b32 v60, 0
    v_mov_b32 v10, 0
    v_mov_b32 v200, 0
    v_mov_b32 v61, 0
    v_mov_b32 v11, 0
    v_mov_b32 v201, 0
    v_mov_b32 v62, 0
    v_mov_b32 v12, 0
    v_mov_b32 v202, 0
    v_mov_b32 v63, 0
    v_mov_b32 v13, 0
    v_mov_b32 v203, 0
    s_mov_b32 s101, 0
    s_cmp_lg_u32 s57, 0
    s_cbranch_scc1 Lpb_51
    v_lshlrev_b32 v9, 3, v3
    s_lshl_b32 s49, s49, 7
    s_mov_b32 s16, s30
    s_and_b32 s17, s31, 0xffff
    s_mov_b32 s18, 1024
    s_mov_b32 s19, 0x20000
    buffer_load_dwordx2 v[10:11], v9, s[16:19], s49 offen
    s_cmp_gt_u32 s99, s65
    s_cbranch_scc1 Lpy_52
    s_lshl_b32 s65, s99, 10
    s_add_u32 s49, s49, s65
    s_mov_b32 s16, s36
    s_and_b32 s17, s37, 0xffff
    s_mov_b32 s18, 2048
    s_mov_b32 s19, 0x20000
    buffer_load_dwordx2 v[12:13], v9, s[16:19], s49 offen
    s_branch Lpb_51
Lpy_52:
    s_lshr_b32 s65, s49, 8
    s_lshl_b32 s65, s65, 15
    s_and_b32 s49, s49, 128
    s_lshl_b32 s49, s49, 1
    s_add_u32 s49, s49, s65
    s_add_u32 s49, s49, s100
    v_lshlrev_b32 v9, 4, v3
    s_mov_b32 s101, 1
Lpb_51:
    s_mov_b32 s48, 200000
Lpoll_53:
    buffer_load_dwordx4 v[48:51], v6, s[12:15], s54 offen sc1
    buffer_load_dwordx4 v[52:55], v6, s[12:15], s55 offen sc1
    buffer_load_dwordx4 v[56:59], v6, s[12:15], s56 offen sc1
    s_mov_b32 exec_hi, 0xffff
    buffer_load_dwordx4 v[60:63], v7, s[12:15], s57 offen sc1
    s_mov_b32 exec_hi, -1
    s_cmp_eq_u32 s101, 0
    s_cbranch_scc1 Lpn_54
    buffer_load_dwordx4 v[200:203], v9, s[12:15], s49 offen offset:2048 sc1
Lpn_54:
    s_waitcnt vmcnt(0)
    v_max3_u32 v70, v48, v49, v50
    v_max3_u32 v70, v70, v51, v52
    v_max3_u32 v70, v70, v53, v54
    v_max3_u32 v70, v70, v55, v56
    v_max3_u32 v70, v70, v57, v58
    v_max3_u32 v70, v70, v59, v60
    v_max3_u32 v70, v70, v61, v62
    v_max3_u32 v70, v70, v63, v200
    v_max3_u32 v70, v70, v201, v202
    v_max_u32 v70, v70, v203
    v_cmp_eq_u32 vcc, -1, v70
    s_cbranch_vccz Lok_55
    s_sub_u32 s48, s48, 1
    s_cmp_lg_u32 s48, 0
    s_cbranch_scc1 Lpoll_53
Lok_55:
    v_add_f32 v48, v48, v52
    v_add_f32 v56, v56, v60
    v_add_f32 v49, v49, v53
    v_add_f32 v57, v57, v61
    v_add_f32 v50, v50, v54
    v_add_f32 v58, v58, v62
    v_add_f32 v51, v51, v55
    v_add_f32 v59, v59, v63
    v_add_f32 v48, v48, v56
    v_add_f32 v49, v49, v57
    v_add_f32 v50, v50, v58
    v_add_f32 v51, v51, v59
    v_lshlrev_b32 v52, 16, v10
    v_and_b32 v53, 0xffff0000, v10
    v_lshlrev_b32 v56, 16, v12
    v_and_b32 v57, 0xffff0000, v12
    v_lshlrev_b32 v54, 16, v11
    v_and_b32 v55, 0xffff0000, v11
    v_lshlrev_b32 v58, 16, v13
    v_and_b32 v59, 0xffff0000, v13
    v_mov_b32 v64, v48
    v_mov_b32 v65, v49
    v_mov_b32 v66, v50
    v_mov_b32 v67, v51
    v_permlane16_swap_b32 v64, v48
    v_permlane16_swap_b32 v65, v49
    v_permlane16_swap_b32 v66, v50
    v_permlane16_swap_b32 v67, v51
    v_add_f32 v48, v64, v48
    v_add_f32 v49, v65, v49
    v_add_f32 v50, v66, v50
    v_add_f32 v51, v67, v51
    v_add_f32 v52, v52, v56
    v_add_f32 v53, v53, v57
    v_add_f32 v54, v54, v58
    v_add_f32 v55, v55, v59
    v_add_f32 v52, v52, v200
    v_add_f32 v53, v53, v201
    v_add_f32 v54, v54, v202
    v_add_f32 v55, v55, v203
    v_mov_b32 v64, v48
    v_mov_b32 v65, v49
    v_mov_b32 v66, v50
    v_mov_b32 v67, v51
    v_permlane32_swap_b32 v64, v48
    v_permlane32_swap_b32 v65, v49
    v_permlane32_swap_b32 v66, v50
    v_permlane32_swap_b32 v67, v51
    v_add_f32 v48, v64, v48
    v_add_f32 v49, v65, v49
    v_add_f32 v50, v66, v50
    v_add_f32 v51, v67, v51
    s_lshl_b32 s54, s38, 8
    s_add_u32 s54, s54, s61
    s_add_u32 s54, s54, s46
    v_lshlrev_b32 v9, 4, v3
    v_add_f32 v48, v48, v52
    v_add_f32 v49, v49, v53
    v_add_f32 v50, v50, v54
    v_add_f32 v51, v51, v55
    s_mov_b64 exec, 0xffff
    buffer_store_dwordx4 v[48:51], v9, s[12:15], s54 offen offset:2048 sc1
    s_mov_b64 exec, -1
    s_branch L_G2
L_G2:
    v_lshlrev_b32 v1, 4, v0
    v_and_b32 v70, 15, v0
    v_lshrrev_b32 v71, 4, v0
    v_add_u32 v48, 0, v71
    v_xor_b32 v48, v48, v70
    v_lshlrev_b32 v48, 4, v48
    v_lshl_add_u32 v2, v71, 8, v48
    v_add_u32 v48, 4, v71
    v_xor_b32 v48, v48, v70
    v_lshlrev_b32 v48, 4, v48
    v_lshl_add_u32 v3, v71, 8, v48
    v_add_u32 v48, 8, v71
    v_xor_b32 v48, v48, v70
    v_lshlrev_b32 v48, 4, v48
    v_lshl_add_u32 v4, v71, 8, v48
    v_add_u32 v48, 12, v71
    v_xor_b32 v48, v48, v70
    v_lshlrev_b32 v48, 4, v48
    v_lshl_add_u32 v5, v71, 8, v48
    v_add_u32 v48, 0, v71
    v_xor_b32 v48, v48, v70
    v_lshlrev_b32 v48, 4, v48
    v_lshl_add_u32 v48, v70, 8, v48
    v_add_u32 v6, s43, v48
    v_add_u32 v48, 4, v71
    v_xor_b32 v48, v48, v70
    v_lshlrev_b32 v48, 4, v48
    v_lshl_add_u32 v48, v70, 8, v48
    v_add_u32 v7, s43, v48
    v_add_u32 v48, 8, v71
    v_xor_b32 v48, v48, v70
    v_lshlrev_b32 v48, 4, v48
    v_lshl_add_u32 v48, v70, 8, v48
    v_add_u32 v8, s43, v48
    v_add_u32 v48, 12, v71
    v_xor_b32 v48, v48, v70
    v_lshlrev_b32 v48, 4, v48
    v_lshl_add_u32 v48, v70, 8, v48
    v_add_u32 v9, s43, v48
    v_and_b32 v48, 7, v70
    v_mov_b32 v49, 0xffff
    v_mov_b32 v50, 0xffff0000
    v_mov_b32 v10, 0
    v_cmp_eq_u32 vcc, 0, v48
s_nop 1
    v_cndmask_b32 v10, v10, v49, vcc
    v_cmp_eq_u32 vcc, 1, v48
s_nop 1
    v_cndmask_b32 v10, v10, v50, vcc
    v_mov_b32 v11, 0
    v_cmp_eq_u32 vcc, 2, v48
s_nop 1
    v_cndmask_b32 v11, v11, v49, vcc
    v_cmp_eq_u32 vcc, 3, v48
s_nop 1
    v_cndmask_b32 v11, v11, v50, vcc
    v_mov_b32 v12, 0
    v_cmp_eq_u32 vcc, 4, v48
s_nop 1
    v_cndmask_b32 v12, v12, v49, vcc
    v_cmp_eq_u32 vcc, 5, v48
s_nop 1
    v_cndmask_b32 v12, v12, v50, vcc
    v_mov_b32 v13, 0
    v_cmp_eq_u32 vcc, 6, v48
s_nop 1
    v_cndmask_b32 v13, v13, v49, vcc
    v_cmp_eq_u32 vcc, 7, v48
s_nop 1
    v_cndmask_b32 v13, v13, v50, vcc
    s_mul_i32 s54, s38, 1152
    s_add_u32 s54, s54, 147456
    v_and_b32 v48, 1, v71
    v_mul_u32_u24 v48, 576, v48
    v_lshrrev_b32 v49, 1, v71
    v_lshl_add_u32 v49, v70, 1, v49
    v_lshl_add_u32 v48, v49, 2, v48
    v_add_u32 v14, s54, v48
    v_lshrrev_b32 v48, 3, v70
    v_lshl_add_u32 v48, v48, 2, v71
    v_mul_u32_u24 v48, 144, v48
    v_add_u32 v15, s54, v48
    s_cmp_lg_u32 s38, 0
    s_cbranch_scc1 Lg2_56
    v_lshrrev_b32 v64, 5, v0
    v_and_b32 v65, 31, v0
    v_lshlrev_b32 v70, 18, v64
    v_lshl_add_u32 v70, v65, 4, v70
    s_lshr_b32 s54, s40, 2
    s_lshl_b32 s54, s54, 3
    s_add_u32 s54, s54, 7
    s_lshl_b32 s54, s54, 14
    s_bfe_u32 s55, s40, 0x10001
    s_lshl_b32 s55, s55, 9
    s_add_u32 s54, s54, s55
    s_add_u32 s54, s54, s46
    v_lshlrev_b32 v64, 8, v64
    v_lshl_add_u32 v64, v65, 3, v64
    v_add_u32 v64, 156224, v64
    s_mov_b32 s48, 200000
Lpoll_57:
    buffer_load_dwordx4 v[48:51], v70, s[12:15], s54 offen offset:2048 sc1
    s_add_u32 s55, s54, 524288
    buffer_load_dwordx4 v[52:55], v70, s[12:15], s55 offen offset:2048 sc1
    s_add_u32 s55, s54, 1048576
    buffer_load_dwordx4 v[56:59], v70, s[12:15], s55 offen offset:2048 sc1
    s_add_u32 s55, s54, 1572864
    buffer_load_dwordx4 v[60:63], v70, s[12:15], s55 offen offset:2048 sc1
    s_add_u32 s55, s54, 2097152
    buffer_load_dwordx4 v[16:19], v70, s[12:15], s55 offen offset:2048 sc1
    s_add_u32 s55, s54, 2621440
    buffer_load_dwordx4 v[20:23], v70, s[12:15], s55 offen offset:2048 sc1
    s_add_u32 s55, s54, 3145728
    buffer_load_dwordx4 v[24:27], v70, s[12:15], s55 offen offset:2048 sc1
    s_add_u32 s55, s54, 3670016
    buffer_load_dwordx4 v[28:31], v70, s[12:15], s55 offen offset:2048 sc1
    s_waitcnt vmcnt(0)
    v_max3_u32 v71, v48, v49, v50
    v_max3_u32 v71, v71, v51, v52
    v_max3_u32 v71, v71, v53, v54
    v_max3_u32 v71, v71, v55, v56
    v_max3_u32 v71, v71, v57, v58
    v_max3_u32 v71, v71, v59, v60
    v_max3_u32 v71, v71, v61, v62
    v_max3_u32 v71, v71, v63, v16
    v_max3_u32 v71, v71, v17, v18
    v_max3_u32 v71, v71, v19, v20
    v_max3_u32 v71, v71, v21, v22
    v_max3_u32 v71, v71, v23, v24
    v_max3_u32 v71, v71, v25, v26
    v_max3_u32 v71, v71, v27, v28
    v_max3_u32 v71, v71, v29, v30
    v_max_u32 v71, v71, v31
    v_cmp_eq_u32 vcc, -1, v71
    s_cbranch_vccz Lok_58
    s_sub_u32 s48, s48, 1
    s_cmp_lg_u32 s48, 0
    s_cbranch_scc1 Lpoll_57
Lok_58:
    v_add_f32 v48, v48, v52
    v_add_f32 v56, v56, v60
    v_add_f32 v16, v16, v20
    v_add_f32 v24, v24, v28
    v_add_f32 v49, v49, v53
    v_add_f32 v57, v57, v61
    v_add_f32 v17, v17, v21
    v_add_f32 v25, v25, v29
    v_add_f32 v50, v50, v54
    v_add_f32 v58, v58, v62
    v_add_f32 v18, v18, v22
    v_add_f32 v26, v26, v30
    v_add_f32 v51, v51, v55
    v_add_f32 v59, v59, v63
    v_add_f32 v19, v19, v23
    v_add_f32 v27, v27, v31
    v_add_f32 v48, v48, v56
    v_add_f32 v16, v16, v24
    v_add_f32 v49, v49, v57
    v_add_f32 v17, v17, v25
    v_add_f32 v50, v50, v58
    v_add_f32 v18, v18, v26
    v_add_f32 v51, v51, v59
    v_add_f32 v19, v19, v27
    v_add_f32 v48, v48, v16
    v_add_f32 v49, v49, v17
    v_add_f32 v50, v50, v18
    v_add_f32 v51, v51, v19
    s_and_b32 s54, s40, 1
    s_add_u32 s54, s54, s39
    s_cmp_lg_u32 s54, 0
    s_cbranch_scc1 Lpub_59
    s_add_u32 s54, s61, s46
    buffer_store_dwordx4 v[48:51], v1, s[12:15], s54 offen offset:2048 sc1
    s_cmp_lg_u32 s99, 1
    s_cbranch_scc1 Lpub_59
    v_cvt_pk_bf16_f32 v52, v48, v49
    v_cvt_pk_bf16_f32 v53, v50, v51
    s_mov_b32 s16, s32
    s_and_b32 s17, s33, 0xffff
    s_mov_b32 s18, 2048
    s_mov_b32 s19, 0x20000
    s_lshr_b32 s54, s40, 1
    s_lshl_b32 s54, s54, 8
    v_lshlrev_b32 v71, 3, v0
    s_mov_b32 exec_hi, 0
    buffer_store_dwordx2 v[52:53], v71, s[16:19], s54 offen
    s_mov_b32 exec_hi, -1
Lpub_59:
    v_mov_b32 v56, v64
    v_cvt_pk_bf16_f32 v52, v48, v49
    v_cvt_pk_bf16_f32 v53, v50, v51
    ds_write_b64 v56, v[52:53]
    v_lshlrev_b32 v48, 16, v52
    v_and_b32 v49, 0xffff0000, v52
    v_lshlrev_b32 v50, 16, v53
    v_and_b32 v51, 0xffff0000, v53
    v_add_f32 v68, v48, v49
    v_mul_f32 v69, v48, v48
    v_add_f32 v68, v68, v50
    v_fmac_f32 v69, v49, v49
    v_add_f32 v68, v68, v51
    v_fmac_f32 v69, v50, v50
    v_fmac_f32 v69, v51, v51
    v_add_f32_dpp v68, v68, v68 row_ror:8 row_mask:0xf bank_mask:0xf
s_nop 0
    v_add_f32_dpp v69, v69, v69 row_ror:8 row_mask:0xf bank_mask:0xf
    v_add_f32_dpp v68, v68, v68 row_ror:4 row_mask:0xf bank_mask:0xf
s_nop 0
    v_add_f32_dpp v69, v69, v69 row_ror:4 row_mask:0xf bank_mask:0xf
    v_add_f32_dpp v68, v68, v68 row_ror:2 row_mask:0xf bank_mask:0xf
s_nop 0
    v_add_f32_dpp v69, v69, v69 row_ror:2 row_mask:0xf bank_mask:0xf
    v_add_f32_dpp v68, v68, v68 row_ror:1 row_mask:0xf bank_mask:0xf
s_nop 0
    v_add_f32_dpp v69, v69, v69 row_ror:1 row_mask:0xf bank_mask:0xf
    v_mov_b32 v70, v68
    v_mov_b32 v71, v69
s_nop 0
    v_permlane16_swap_b32 v70, v68
    v_permlane16_swap_b32 v71, v69
    v_add_f32 v68, v70, v68
    v_add_f32 v69, v71, v69
Lg2_56:
    s_mov_b32 s100, s46
    s_mov_b32 s41, s99
    s_cmp_eq_u32 s99, 0
    s_mov_b32 s46, 5242880
    s_cselect_b32 s46, 8192, s46
    s_waitcnt lgkmcnt(0)
    s_branch L_QE
L_end:
L_exit:
    s_endpgm
.section .rodata,"a"
.p2align 6
.amdhsa_kernel interleave_layers__mha_block_cached__dense_activation_gelu__decode_kernel
  .amdhsa_next_free_vgpr 512
  .amdhsa_next_free_sgpr 102
  .amdhsa_accum_offset 256
  .amdhsa_group_segment_fixed_size 0
  .amdhsa_kernarg_size 104
  .amdhsa_user_sgpr_count 2
  .amdhsa_user_sgpr_kernarg_segment_ptr 1
  .amdhsa_system_sgpr_workgroup_id_x 1
.end_amdhsa_kernel
```
